```python
import torch

def _softmax(x, axis=-1):
    return torch.softmax(x, dim=axis)
def _gelu(x):
    return torch.nn.functional.gelu(x, approximate="tanh")
def _silu(x):
    return torch.nn.functional.silu(x)
def _sigmoid(x):
    return torch.sigmoid(x)
def _layernorm(x, axis=-1, eps=1e-5):
    m = x.mean(dim=axis, keepdim=True)
    v = x.var(dim=axis, keepdim=True, unbiased=False)
    return (x - m) / torch.sqrt(v + eps)
def _scatter_add(tgt, idx, src, axis=0):
    return tgt.clone().index_add_(axis, idx, src)
def _segment_sum(src, seg, n):
    out = torch.zeros((n,) + src.shape[1:], dtype=src.dtype)
    return out.index_add_(0, seg, src)
def _pad(x, pw):
    flat = tuple(v for pair in reversed(pw) for v in pair)
    return torch.nn.functional.pad(x, flat)

kernel_name = 'parallel_sum__ssm_conv_h3__dense_activation_gelu__prompt'

def setup_inputs():

    _w = (lambda a: (lambda t: t.to(torch.bfloat16) if t.is_floating_point() else t)(torch.as_tensor(a)))
    def _A_setup():
        B, S, D = 1, 2048, 640
        ks = 4
        return {
            "q": _w((lambda *s: torch.randn(*s, dtype=torch.bfloat16) * 0.05)(B, S, D)),
            "k": _w((lambda *s: torch.randn(*s, dtype=torch.bfloat16) * 0.2)(B, S, D)),
            "v": _w((lambda *s: torch.randn(*s, dtype=torch.bfloat16) * 0.2)(B, S, D)),
            "shift_k": _w((lambda *s: torch.randn(*s, dtype=torch.bfloat16) * 0.2)(D, ks) * 0.5),
            "ssm_k": _w((lambda *s: torch.randn(*s, dtype=torch.bfloat16) * 0.8)(D, S) * (1.0 / S ** 0.5)),
            "ssm_D": _w((lambda *s: torch.randn(*s, dtype=torch.bfloat16) * 0.2)(D)),
        }
    _A_in = _A_setup()

    def _B_setup():
        B, S, D, F = 1, 2048, 640, 1536
        return {
            "x": _w((lambda *s: torch.randn(*s, dtype=torch.bfloat16) * 0.05)(B, S, D)),
            "w1": _w((lambda *s: torch.randn(*s, dtype=torch.bfloat16) * 0.4)(D, F) * (D ** -0.5)),
            "b1": _w((lambda *s: torch.randn(*s, dtype=torch.bfloat16) * 12.8)(F) * 0.01),
            "w2": _w((lambda *s: torch.randn(*s, dtype=torch.bfloat16) * 0.2)(F, D) * (F ** -0.5)),
            "b2": _w((lambda *s: torch.randn(*s, dtype=torch.bfloat16) * 3.2)(D) * 0.01),
        }
    _B_in = _B_setup()

    return {
        "A_q": _A_in["q"],
        "A_k": _A_in["k"],
        "A_v": _A_in["v"],
        "A_shift_k": _A_in["shift_k"],
        "A_ssm_k": _A_in["ssm_k"],
        "A_ssm_D": _A_in["ssm_D"],
        "B_x": _B_in["x"],
        "B_w1": _B_in["w1"],
        "B_b1": _B_in["b1"],
        "B_w2": _B_in["w2"],
        "B_b2": _B_in["b2"],
    }

def reference(A_q, A_k, A_v, A_shift_k, A_ssm_k, A_ssm_D, B_x, B_w1, B_b1, B_w2, B_b2):
    def _A_ref(q, k, v, shift_k, ssm_k, ssm_D):
        B, S, D = q.shape
        ks = shift_k.shape[-1]
        k_pad = _pad(k, ((0, 0), (ks - 1, 0), (0, 0)))
        k_shift = torch.zeros_like(k)
        for t in range(ks):
            k_shift = k_shift + k_pad[:, t:t + S, :] * shift_k[:, ks - 1 - t][None, None, :]
        kv = k_shift * v
        L = 2 * S
        kv_pad = _pad(kv, ((0, 0), (0, S), (0, 0)))
        kf_pad = _pad(ssm_k, ((0, 0), (0, S)))
        kv_f = (lambda x, axes=(-2,-1): torch.fft.rfft2(x.float(), dim=axes))(kv_pad[:, None, :, :], axes=(1, 2))
        kf_f = (lambda x, axes=(-2,-1): torch.fft.rfft2(x.float(), dim=axes))(kf_pad[:, None, :], axes=(1, 2))
        kf_f = (lambda x, *d: x.permute(*d))(kf_f, 1, 2, 0)
        y_f = kv_f * kf_f[None, :, :, :]
        y = (lambda x, s, axes=(-2,-1): torch.fft.irfft2(x, s=s, dim=axes).to(torch.bfloat16))(y_f, (1, L), axes=(1, 2))[:, 0, :S, :]
        y = y + kv * ssm_D[None, None, :]
        return q * y

    def _B_ref(x, w1, b1, w2, b2):
        h = torch.einsum("bsd,df->bsf", x, w1) + b1
        h = _gelu(h)
        return torch.einsum("bsf,fd->bsd", h, w2) + b2

    x = A_q
    xn = _layernorm(x, axis=-1)
    return x + _A_ref(xn, A_k, A_v, A_shift_k, A_ssm_k, A_ssm_D) + _B_ref(xn, B_w1, B_b1, B_w2, B_b2)
```

```asm
; @launch kernel=k1_kernel grid=(256,1,1) block=(512,1,1) lds=161856
; @launch kernel=k2_kernel grid=(256,1,1) block=(512,1,1) lds=160832
.amdgcn_target "amdgcn-amd-amdhsa--gfx950"
.text
  .globl k1_kernel
  .p2align 8
  .type k1_kernel,@function
k1_kernel:
  s_cmp_ge_u32 s2, 256
  s_cbranch_scc1 K1_END
  s_load_dwordx2 s[20:21], s[0:1], 0
  s_load_dwordx2 s[24:25], s[0:1], 56
  s_load_dwordx2 s[44:45], s[0:1], 72
  s_load_dwordx2 s[28:29], s[0:1], 8
  s_load_dwordx2 s[32:33], s[0:1], 16
  s_load_dwordx2 s[36:37], s[0:1], 24
  s_load_dwordx2 s[40:41], s[0:1], 64
  s_load_dwordx2 s[48:49], s[0:1], 104
  s_mov_b32 s22, 0x280000
  s_mov_b32 s23, 0x00020000
  s_mov_b32 s26, 0x1e0000
  s_mov_b32 s27, 0x00020000
  s_mov_b32 s46, 0x1e0000
  s_mov_b32 s47, 0x00020000
  s_mov_b32 s30, 0x280000
  s_mov_b32 s31, 0x00020000
  s_mov_b32 s34, 0x280000
  s_mov_b32 s35, 0x00020000
  s_mov_b32 s38, 0x1400
  s_mov_b32 s39, 0x00020000
  s_mov_b32 s42, 0xc00
  s_mov_b32 s43, 0x00020000
  s_mov_b32 s50, 0xe50000
  s_mov_b32 s51, 0x00020000
  v_lshrrev_b32 v2, 6, v0
  v_and_b32 v1, 63, v0
  s_and_b32 s3, s2, 7
  v_readfirstlane_b32 s52, v2
  s_lshr_b32 s4, s2, 3
  s_and_b32 s5, s3, 3
  s_lshl_b32 s5, s5, 3
  s_and_b32 s6, s4, 7
  s_add_u32 s55, s5, s6
  s_lshr_b32 s5, s3, 2
  s_lshl_b32 s5, s5, 2
  s_lshr_b32 s6, s4, 3
  s_add_u32 s56, s5, s6
  s_and_b32 s53, s52, 1
  s_lshr_b32 s54, s52, 1
  s_lshl_b32 s57, s52, 11
  s_lshl_b32 s58, s55, 6
  s_mov_b32 s63, 0x3f803f80
  s_cmp_ge_u32 s52, 4
  s_cbranch_scc1 K1_HELP
  v_lshrrev_b32 v2, 3, v1
  v_and_b32 v3, 7, v1
  v_lshrrev_b32 v7, 4, v1
  s_lshl_b32 s5, s52, 4
  s_add_u32 s6, s5, s58
  v_add_u32 v60, s6, v2
  v_mul_u32_u24 v60, 1280, v60
  v_xor_b32 v61, v3, v7
  v_lshl_add_u32 v4, v61, 4, v60
  v_xor_b32 v61, 4, v61
  v_lshl_add_u32 v5, v61, 4, v60
  v_add_u32 v5, 10240, v5
  v_add_u32 v60, s5, v2
  v_mul_u32_u24 v60, 3072, v60
  v_and_b32 v61, 1, v7
  v_lshlrev_b32 v61, 2, v61
  v_xor_b32 v61, v3, v61
  v_lshl_add_u32 v6, v61, 4, v60
  s_mul_i32 s5, s56, 384
  v_add_u32 v6, s5, v6
  s_waitcnt lgkmcnt(0)
  s_mov_b32 s60, 0
  s_mov_b32 s61, 0
  s_mov_b32 s62, 24576
  s_add_u32 m0, s57, 0
  s_nop 0
  buffer_load_dwordx4 v4, s[20:23], s60 offen lds
  s_add_u32 m0, s57, 1024
  s_nop 0
  buffer_load_dwordx4 v5, s[20:23], s60 offen lds
  s_add_u32 m0, s57, 8192
  s_nop 0
  buffer_load_dwordx4 v6, s[24:27], s61 offen offset:0 lds
  s_add_u32 m0, s57, 16256
  s_nop 0
  buffer_load_dwordx4 v6, s[24:27], s61 offen offset:128 lds
  s_add_u32 m0, s57, 24320
  s_nop 0
  buffer_load_dwordx4 v6, s[24:27], s61 offen offset:256 lds
  s_add_u32 m0, s57, 9216
  s_nop 0
  buffer_load_dwordx4 v6, s[24:27], s62 offen offset:0 lds
  s_add_u32 m0, s57, 17280
  s_nop 0
  buffer_load_dwordx4 v6, s[24:27], s62 offen offset:128 lds
  s_add_u32 m0, s57, 25344
  s_nop 0
  buffer_load_dwordx4 v6, s[24:27], s62 offen offset:256 lds
  s_mov_b32 s60, 128
  s_mov_b32 s61, 196608
  s_mov_b32 s62, 221184
  s_add_u32 m0, s57, 32768
  s_nop 0
  buffer_load_dwordx4 v4, s[20:23], s60 offen lds
  s_add_u32 m0, s57, 33792
  s_nop 0
  buffer_load_dwordx4 v5, s[20:23], s60 offen lds
  s_add_u32 m0, s57, 40960
  s_nop 0
  buffer_load_dwordx4 v6, s[24:27], s61 offen offset:0 lds
  s_add_u32 m0, s57, 49024
  s_nop 0
  buffer_load_dwordx4 v6, s[24:27], s61 offen offset:128 lds
  s_add_u32 m0, s57, 57088
  s_nop 0
  buffer_load_dwordx4 v6, s[24:27], s61 offen offset:256 lds
  s_add_u32 m0, s57, 41984
  s_nop 0
  buffer_load_dwordx4 v6, s[24:27], s62 offen offset:0 lds
  s_add_u32 m0, s57, 50048
  s_nop 0
  buffer_load_dwordx4 v6, s[24:27], s62 offen offset:128 lds
  s_add_u32 m0, s57, 58112
  s_nop 0
  buffer_load_dwordx4 v6, s[24:27], s62 offen offset:256 lds
  s_mov_b32 s60, 256
  s_mov_b32 s61, 393216
  s_mov_b32 s62, 417792
  s_add_u32 m0, s57, 65536
  s_nop 0
  buffer_load_dwordx4 v4, s[20:23], s60 offen lds
  s_add_u32 m0, s57, 66560
  s_nop 0
  buffer_load_dwordx4 v5, s[20:23], s60 offen lds
  s_add_u32 m0, s57, 73728
  s_nop 0
  buffer_load_dwordx4 v6, s[24:27], s61 offen offset:0 lds
  s_add_u32 m0, s57, 81792
  s_nop 0
  buffer_load_dwordx4 v6, s[24:27], s61 offen offset:128 lds
  s_add_u32 m0, s57, 89856
  s_nop 0
  buffer_load_dwordx4 v6, s[24:27], s61 offen offset:256 lds
  s_add_u32 m0, s57, 74752
  s_nop 0
  buffer_load_dwordx4 v6, s[24:27], s62 offen offset:0 lds
  s_add_u32 m0, s57, 82816
  s_nop 0
  buffer_load_dwordx4 v6, s[24:27], s62 offen offset:128 lds
  s_add_u32 m0, s57, 90880
  s_nop 0
  buffer_load_dwordx4 v6, s[24:27], s62 offen offset:256 lds
  v_and_b32 v2, 31, v1
  v_lshrrev_b32 v3, 5, v1
  s_lshl_b32 s16, s53, 5
  v_add_u32 v7, s16, v2
  v_lshlrev_b32 v7, 7, v7
  v_bfe_u32 v60, v2, 1, 3
  v_xor_b32 v60, v60, v3
  s_xor_b32 s16, s52, 0
  s_lshl_b32 s16, s16, 1
  v_xor_b32 v61, s16, v60
  v_lshl_add_u32 v8, v61, 4, v7
  v_add_u32 v24, 0x10000, v8
  s_xor_b32 s16, s52, 1
  s_lshl_b32 s16, s16, 1
  v_xor_b32 v61, s16, v60
  v_lshl_add_u32 v9, v61, 4, v7
  v_add_u32 v25, 0x10000, v9
  s_xor_b32 s16, s52, 2
  s_lshl_b32 s16, s16, 1
  v_xor_b32 v61, s16, v60
  v_lshl_add_u32 v10, v61, 4, v7
  v_add_u32 v26, 0x10000, v10
  s_xor_b32 s16, s52, 3
  s_lshl_b32 s16, s16, 1
  v_xor_b32 v61, s16, v60
  v_lshl_add_u32 v11, v61, 4, v7
  v_add_u32 v27, 0x10000, v11
  v_bfe_u32 v60, v1, 2, 2
  v_and_b32 v61, 3, v1
  v_lshlrev_b32 v61, 3, v61
  v_lshl_add_u32 v61, v60, 7, v61
  v_lshl_add_u32 v61, v3, 10, v61
  v_bfe_u32 v63, v1, 4, 1
  v_lshl_add_u32 v61, v63, 5, v61
  v_lshrrev_b32 v60, 1, v60
  s_mul_i32 s16, s54, 3
  s_add_u32 s16, s16, 0
  s_and_b32 s17, s16, 1
  s_lshr_b32 s16, s16, 1
  s_lshl_b32 s16, s16, 13
  s_add_u32 s16, s16, 8192
  v_xor_b32 v63, s17, v60
  v_lshl_add_u32 v63, v63, 6, v61
  s_xor_b32 s17, s52, 0
  s_lshl_b32 s17, s17, 11
  s_add_u32 s17, s17, s16
  v_add_u32 v12, s17, v63
  v_add_u32 v28, 0x10000, v12
  s_xor_b32 s17, s52, 1
  s_lshl_b32 s17, s17, 11
  s_add_u32 s17, s17, s16
  v_add_u32 v13, s17, v63
  v_add_u32 v29, 0x10000, v13
  s_xor_b32 s17, s52, 2
  s_lshl_b32 s17, s17, 11
  s_add_u32 s17, s17, s16
  v_add_u32 v14, s17, v63
  v_add_u32 v30, 0x10000, v14
  s_xor_b32 s17, s52, 3
  s_lshl_b32 s17, s17, 11
  s_add_u32 s17, s17, s16
  v_add_u32 v15, s17, v63
  v_add_u32 v31, 0x10000, v15
  s_mul_i32 s16, s54, 3
  s_add_u32 s16, s16, 1
  s_and_b32 s17, s16, 1
  s_lshr_b32 s16, s16, 1
  s_lshl_b32 s16, s16, 13
  s_add_u32 s16, s16, 8192
  v_xor_b32 v63, s17, v60
  v_lshl_add_u32 v63, v63, 6, v61
  s_xor_b32 s17, s52, 0
  s_lshl_b32 s17, s17, 11
  s_add_u32 s17, s17, s16
  v_add_u32 v16, s17, v63
  v_add_u32 v32, 0x10000, v16
  s_xor_b32 s17, s52, 1
  s_lshl_b32 s17, s17, 11
  s_add_u32 s17, s17, s16
  v_add_u32 v17, s17, v63
  v_add_u32 v33, 0x10000, v17
  s_xor_b32 s17, s52, 2
  s_lshl_b32 s17, s17, 11
  s_add_u32 s17, s17, s16
  v_add_u32 v18, s17, v63
  v_add_u32 v34, 0x10000, v18
  s_xor_b32 s17, s52, 3
  s_lshl_b32 s17, s17, 11
  s_add_u32 s17, s17, s16
  v_add_u32 v19, s17, v63
  v_add_u32 v35, 0x10000, v19
  s_mul_i32 s16, s54, 3
  s_add_u32 s16, s16, 2
  s_and_b32 s17, s16, 1
  s_lshr_b32 s16, s16, 1
  s_lshl_b32 s16, s16, 13
  s_add_u32 s16, s16, 8192
  v_xor_b32 v63, s17, v60
  v_lshl_add_u32 v63, v63, 6, v61
  s_xor_b32 s17, s52, 0
  s_lshl_b32 s17, s17, 11
  s_add_u32 s17, s17, s16
  v_add_u32 v20, s17, v63
  v_add_u32 v36, 0x10000, v20
  s_xor_b32 s17, s52, 1
  s_lshl_b32 s17, s17, 11
  s_add_u32 s17, s17, s16
  v_add_u32 v21, s17, v63
  v_add_u32 v37, 0x10000, v21
  s_xor_b32 s17, s52, 2
  s_lshl_b32 s17, s17, 11
  s_add_u32 s17, s17, s16
  v_add_u32 v22, s17, v63
  v_add_u32 v38, 0x10000, v22
  s_xor_b32 s17, s52, 3
  s_lshl_b32 s17, s17, 11
  s_add_u32 s17, s17, s16
  v_add_u32 v23, s17, v63
  v_add_u32 v39, 0x10000, v23
  v_mov_b32 v40, 0
  v_mov_b32 v41, 0
  v_mov_b32 v42, 0
  v_mov_b32 v43, 0
  v_mov_b32 v44, 0
  v_mov_b32 v45, 0
  v_mov_b32 v46, 0
  v_mov_b32 v47, 0
  v_mov_b32 v48, 0
  v_mov_b32 v49, 0
  s_waitcnt vmcnt(8)
  s_barrier
  ds_read_b128 v[112:115], v8 offset:0
  ds_read_b64_tr_b16 v[116:117], v12 offset:0
  ds_read_b64_tr_b16 v[118:119], v12 offset:512
  ds_read_b64_tr_b16 v[120:121], v16 offset:0
  ds_read_b64_tr_b16 v[122:123], v16 offset:512
  ds_read_b64_tr_b16 v[124:125], v20 offset:0
  ds_read_b64_tr_b16 v[126:127], v20 offset:512
  ds_read_b128 v[128:131], v9 offset:0
  ds_read_b64_tr_b16 v[132:133], v13 offset:0
  ds_read_b64_tr_b16 v[134:135], v13 offset:512
  ds_read_b64_tr_b16 v[136:137], v17 offset:0
  ds_read_b64_tr_b16 v[138:139], v17 offset:512
  ds_read_b64_tr_b16 v[140:141], v21 offset:0
  ds_read_b64_tr_b16 v[142:143], v21 offset:512
  s_waitcnt vmcnt(8)
  s_mov_b32 s60, 384
  s_mov_b32 s61, 589824
  s_mov_b32 s62, 614400
  s_waitcnt lgkmcnt(7)
  v_mfma_f32_32x32x16_bf16 v[64:79], v[116:119], v[112:115], 0
  s_add_u32 m0, s57, 98304
  ds_read_b128 v[144:147], v10 offset:0
  buffer_load_dwordx4 v4, s[20:23], s60 offen lds
  ds_read_b64_tr_b16 v[148:149], v14 offset:0
  ds_read_b64_tr_b16 v[150:151], v14 offset:512
  v_dot2_f32_bf16 v44, v116, s63, v44
  v_dot2_f32_bf16 v40, v112, s63, v40
  v_dot2_f32_bf16 v46, v120, s63, v46
  v_dot2_f32_bf16 v42, v112, v112, v42
  v_dot2_f32_bf16 v48, v124, s63, v48
  v_dot2_f32_bf16 v41, v113, s63, v41
  v_mfma_f32_32x32x16_bf16 v[80:95], v[120:123], v[112:115], 0
  s_add_u32 m0, s57, 99328
  ds_read_b64_tr_b16 v[152:153], v18 offset:0
  buffer_load_dwordx4 v5, s[20:23], s60 offen lds
  ds_read_b64_tr_b16 v[154:155], v18 offset:512
  v_dot2_f32_bf16 v45, v117, s63, v45
  v_dot2_f32_bf16 v43, v113, v113, v43
  v_dot2_f32_bf16 v47, v121, s63, v47
  v_dot2_f32_bf16 v40, v114, s63, v40
  v_dot2_f32_bf16 v49, v125, s63, v49
  v_dot2_f32_bf16 v42, v114, v114, v42
  v_dot2_f32_bf16 v44, v118, s63, v44
  v_mfma_f32_32x32x16_bf16 v[96:111], v[124:127], v[112:115], 0
  ds_read_b64_tr_b16 v[156:157], v22 offset:0
  ds_read_b64_tr_b16 v[158:159], v22 offset:512
  v_dot2_f32_bf16 v41, v115, s63, v41
  v_dot2_f32_bf16 v46, v122, s63, v46
  v_dot2_f32_bf16 v43, v115, v115, v43
  v_dot2_f32_bf16 v48, v126, s63, v48
  v_dot2_f32_bf16 v45, v119, s63, v45
  v_dot2_f32_bf16 v47, v123, s63, v47
  v_dot2_f32_bf16 v49, v127, s63, v49
  s_waitcnt lgkmcnt(7)
  v_mfma_f32_32x32x16_bf16 v[64:79], v[132:135], v[128:131], v[64:79]
  s_add_u32 m0, s57, 106496
  ds_read_b128 v[112:115], v11 offset:0
  buffer_load_dwordx4 v6, s[24:27], s61 offen offset:0 lds
  ds_read_b64_tr_b16 v[116:117], v15 offset:0
  ds_read_b64_tr_b16 v[118:119], v15 offset:512
  v_dot2_f32_bf16 v40, v128, s63, v40
  v_dot2_f32_bf16 v42, v128, v128, v42
  v_mfma_f32_32x32x16_bf16 v[80:95], v[136:139], v[128:131], v[80:95]
  s_add_u32 m0, s57, 114560
  ds_read_b64_tr_b16 v[120:121], v19 offset:0
  buffer_load_dwordx4 v6, s[24:27], s61 offen offset:128 lds
  ds_read_b64_tr_b16 v[122:123], v19 offset:512
  v_dot2_f32_bf16 v41, v129, s63, v41
  v_dot2_f32_bf16 v43, v129, v129, v43
  v_dot2_f32_bf16 v40, v130, s63, v40
  v_mfma_f32_32x32x16_bf16 v[96:111], v[140:143], v[128:131], v[96:111]
  ds_read_b64_tr_b16 v[124:125], v23 offset:0
  ds_read_b64_tr_b16 v[126:127], v23 offset:512
  v_dot2_f32_bf16 v42, v130, v130, v42
  v_dot2_f32_bf16 v41, v131, s63, v41
  v_dot2_f32_bf16 v43, v131, v131, v43
  s_waitcnt lgkmcnt(7)
  v_mfma_f32_32x32x16_bf16 v[64:79], v[148:151], v[144:147], v[64:79]
  s_add_u32 m0, s57, 122624
  ds_read_b128 v[128:131], v8 offset:32768
  buffer_load_dwordx4 v6, s[24:27], s61 offen offset:256 lds
  ds_read_b64_tr_b16 v[132:133], v12 offset:32768
  ds_read_b64_tr_b16 v[134:135], v12 offset:33280
  v_dot2_f32_bf16 v44, v148, s63, v44
  v_dot2_f32_bf16 v46, v152, s63, v46
  v_dot2_f32_bf16 v48, v156, s63, v48
  v_dot2_f32_bf16 v45, v149, s63, v45
  v_mfma_f32_32x32x16_bf16 v[80:95], v[152:155], v[144:147], v[80:95]
  s_add_u32 m0, s57, 107520
  ds_read_b64_tr_b16 v[136:137], v16 offset:32768
  buffer_load_dwordx4 v6, s[24:27], s62 offen offset:0 lds
  ds_read_b64_tr_b16 v[138:139], v16 offset:33280
  v_dot2_f32_bf16 v47, v153, s63, v47
  v_dot2_f32_bf16 v49, v157, s63, v49
  v_dot2_f32_bf16 v44, v150, s63, v44
  v_dot2_f32_bf16 v46, v154, s63, v46
  v_mfma_f32_32x32x16_bf16 v[96:111], v[156:159], v[144:147], v[96:111]
  ds_read_b64_tr_b16 v[140:141], v20 offset:32768
  ds_read_b64_tr_b16 v[142:143], v20 offset:33280
  v_dot2_f32_bf16 v48, v158, s63, v48
  v_dot2_f32_bf16 v45, v151, s63, v45
  v_dot2_f32_bf16 v47, v155, s63, v47
  v_dot2_f32_bf16 v49, v159, s63, v49
  s_waitcnt lgkmcnt(7)
  v_mfma_f32_32x32x16_bf16 v[64:79], v[116:119], v[112:115], v[64:79]
  s_add_u32 m0, s57, 115584
  ds_read_b128 v[144:147], v9 offset:32768
  buffer_load_dwordx4 v6, s[24:27], s62 offen offset:128 lds
  ds_read_b64_tr_b16 v[148:149], v13 offset:32768
  ds_read_b64_tr_b16 v[150:151], v13 offset:33280
  v_mfma_f32_32x32x16_bf16 v[80:95], v[120:123], v[112:115], v[80:95]
  s_add_u32 m0, s57, 123648
  ds_read_b64_tr_b16 v[152:153], v17 offset:32768
  buffer_load_dwordx4 v6, s[24:27], s62 offen offset:256 lds
  ds_read_b64_tr_b16 v[154:155], v17 offset:33280
  v_mfma_f32_32x32x16_bf16 v[96:111], v[124:127], v[112:115], v[96:111]
  ds_read_b64_tr_b16 v[156:157], v21 offset:32768
  ds_read_b64_tr_b16 v[158:159], v21 offset:33280
  s_waitcnt vmcnt(8)
  s_barrier
  s_mov_b32 s60, 512
  s_mov_b32 s61, 786432
  s_mov_b32 s62, 811008
  s_waitcnt lgkmcnt(7)
  v_mfma_f32_32x32x16_bf16 v[64:79], v[132:135], v[128:131], v[64:79]
  s_add_u32 m0, s57, 0
  ds_read_b128 v[112:115], v10 offset:32768
  buffer_load_dwordx4 v4, s[20:23], s60 offen lds
  ds_read_b64_tr_b16 v[116:117], v14 offset:32768
  ds_read_b64_tr_b16 v[118:119], v14 offset:33280
  v_dot2_f32_bf16 v44, v132, s63, v44
  v_dot2_f32_bf16 v40, v128, s63, v40
  v_dot2_f32_bf16 v46, v136, s63, v46
  v_dot2_f32_bf16 v42, v128, v128, v42
  v_dot2_f32_bf16 v48, v140, s63, v48
  v_dot2_f32_bf16 v41, v129, s63, v41
  v_mfma_f32_32x32x16_bf16 v[80:95], v[136:139], v[128:131], v[80:95]
  s_add_u32 m0, s57, 1024
  ds_read_b64_tr_b16 v[120:121], v18 offset:32768
  buffer_load_dwordx4 v5, s[20:23], s60 offen lds
  ds_read_b64_tr_b16 v[122:123], v18 offset:33280
  v_dot2_f32_bf16 v45, v133, s63, v45
  v_dot2_f32_bf16 v43, v129, v129, v43
  v_dot2_f32_bf16 v47, v137, s63, v47
  v_dot2_f32_bf16 v40, v130, s63, v40
  v_dot2_f32_bf16 v49, v141, s63, v49
  v_dot2_f32_bf16 v42, v130, v130, v42
  v_dot2_f32_bf16 v44, v134, s63, v44
  v_mfma_f32_32x32x16_bf16 v[96:111], v[140:143], v[128:131], v[96:111]
  ds_read_b64_tr_b16 v[124:125], v22 offset:32768
  ds_read_b64_tr_b16 v[126:127], v22 offset:33280
  v_dot2_f32_bf16 v41, v131, s63, v41
  v_dot2_f32_bf16 v46, v138, s63, v46
  v_dot2_f32_bf16 v43, v131, v131, v43
  v_dot2_f32_bf16 v48, v142, s63, v48
  v_dot2_f32_bf16 v45, v135, s63, v45
  v_dot2_f32_bf16 v47, v139, s63, v47
  v_dot2_f32_bf16 v49, v143, s63, v49
  s_waitcnt lgkmcnt(7)
  v_mfma_f32_32x32x16_bf16 v[64:79], v[148:151], v[144:147], v[64:79]
  s_add_u32 m0, s57, 8192
  ds_read_b128 v[128:131], v11 offset:32768
  buffer_load_dwordx4 v6, s[24:27], s61 offen offset:0 lds
  ds_read_b64_tr_b16 v[132:133], v15 offset:32768
  ds_read_b64_tr_b16 v[134:135], v15 offset:33280
  v_dot2_f32_bf16 v40, v144, s63, v40
  v_dot2_f32_bf16 v42, v144, v144, v42
  v_mfma_f32_32x32x16_bf16 v[80:95], v[152:155], v[144:147], v[80:95]
  s_add_u32 m0, s57, 16256
  ds_read_b64_tr_b16 v[136:137], v19 offset:32768
  buffer_load_dwordx4 v6, s[24:27], s61 offen offset:128 lds
  ds_read_b64_tr_b16 v[138:139], v19 offset:33280
  v_dot2_f32_bf16 v41, v145, s63, v41
  v_dot2_f32_bf16 v43, v145, v145, v43
  v_dot2_f32_bf16 v40, v146, s63, v40
  v_mfma_f32_32x32x16_bf16 v[96:111], v[156:159], v[144:147], v[96:111]
  ds_read_b64_tr_b16 v[140:141], v23 offset:32768
  ds_read_b64_tr_b16 v[142:143], v23 offset:33280
  v_dot2_f32_bf16 v42, v146, v146, v42
  v_dot2_f32_bf16 v41, v147, s63, v41
  v_dot2_f32_bf16 v43, v147, v147, v43
  s_waitcnt lgkmcnt(7)
  v_mfma_f32_32x32x16_bf16 v[64:79], v[116:119], v[112:115], v[64:79]
  s_add_u32 m0, s57, 24320
  ds_read_b128 v[144:147], v24 offset:0
  buffer_load_dwordx4 v6, s[24:27], s61 offen offset:256 lds
  ds_read_b64_tr_b16 v[148:149], v28 offset:0
  ds_read_b64_tr_b16 v[150:151], v28 offset:512
  v_dot2_f32_bf16 v44, v116, s63, v44
  v_dot2_f32_bf16 v46, v120, s63, v46
  v_dot2_f32_bf16 v48, v124, s63, v48
  v_dot2_f32_bf16 v45, v117, s63, v45
  v_mfma_f32_32x32x16_bf16 v[80:95], v[120:123], v[112:115], v[80:95]
  s_add_u32 m0, s57, 9216
  ds_read_b64_tr_b16 v[152:153], v32 offset:0
  buffer_load_dwordx4 v6, s[24:27], s62 offen offset:0 lds
  ds_read_b64_tr_b16 v[154:155], v32 offset:512
  v_dot2_f32_bf16 v47, v121, s63, v47
  v_dot2_f32_bf16 v49, v125, s63, v49
  v_dot2_f32_bf16 v44, v118, s63, v44
  v_dot2_f32_bf16 v46, v122, s63, v46
  v_mfma_f32_32x32x16_bf16 v[96:111], v[124:127], v[112:115], v[96:111]
  ds_read_b64_tr_b16 v[156:157], v36 offset:0
  ds_read_b64_tr_b16 v[158:159], v36 offset:512
  v_dot2_f32_bf16 v48, v126, s63, v48
  v_dot2_f32_bf16 v45, v119, s63, v45
  v_dot2_f32_bf16 v47, v123, s63, v47
  v_dot2_f32_bf16 v49, v127, s63, v49
  s_waitcnt lgkmcnt(7)
  v_mfma_f32_32x32x16_bf16 v[64:79], v[132:135], v[128:131], v[64:79]
  s_add_u32 m0, s57, 17280
  ds_read_b128 v[112:115], v25 offset:0
  buffer_load_dwordx4 v6, s[24:27], s62 offen offset:128 lds
  ds_read_b64_tr_b16 v[116:117], v29 offset:0
  ds_read_b64_tr_b16 v[118:119], v29 offset:512
  v_mfma_f32_32x32x16_bf16 v[80:95], v[136:139], v[128:131], v[80:95]
  s_add_u32 m0, s57, 25344
  ds_read_b64_tr_b16 v[120:121], v33 offset:0
  buffer_load_dwordx4 v6, s[24:27], s62 offen offset:256 lds
  ds_read_b64_tr_b16 v[122:123], v33 offset:512
  v_mfma_f32_32x32x16_bf16 v[96:111], v[140:143], v[128:131], v[96:111]
  ds_read_b64_tr_b16 v[124:125], v37 offset:0
  ds_read_b64_tr_b16 v[126:127], v37 offset:512
  s_waitcnt vmcnt(8)
  s_barrier
  s_mov_b32 s60, 640
  s_mov_b32 s61, 983040
  s_mov_b32 s62, 1007616
  s_waitcnt lgkmcnt(7)
  v_mfma_f32_32x32x16_bf16 v[64:79], v[148:151], v[144:147], v[64:79]
  s_add_u32 m0, s57, 32768
  ds_read_b128 v[128:131], v26 offset:0
  buffer_load_dwordx4 v4, s[20:23], s60 offen lds
  ds_read_b64_tr_b16 v[132:133], v30 offset:0
  ds_read_b64_tr_b16 v[134:135], v30 offset:512
  v_dot2_f32_bf16 v44, v148, s63, v44
  v_dot2_f32_bf16 v40, v144, s63, v40
  v_dot2_f32_bf16 v46, v152, s63, v46
  v_dot2_f32_bf16 v42, v144, v144, v42
  v_dot2_f32_bf16 v48, v156, s63, v48
  v_dot2_f32_bf16 v41, v145, s63, v41
  v_mfma_f32_32x32x16_bf16 v[80:95], v[152:155], v[144:147], v[80:95]
  s_add_u32 m0, s57, 33792
  ds_read_b64_tr_b16 v[136:137], v34 offset:0
  buffer_load_dwordx4 v5, s[20:23], s60 offen lds
  ds_read_b64_tr_b16 v[138:139], v34 offset:512
  v_dot2_f32_bf16 v45, v149, s63, v45
  v_dot2_f32_bf16 v43, v145, v145, v43
  v_dot2_f32_bf16 v47, v153, s63, v47
  v_dot2_f32_bf16 v40, v146, s63, v40
  v_dot2_f32_bf16 v49, v157, s63, v49
  v_dot2_f32_bf16 v42, v146, v146, v42
  v_dot2_f32_bf16 v44, v150, s63, v44
  v_mfma_f32_32x32x16_bf16 v[96:111], v[156:159], v[144:147], v[96:111]
  ds_read_b64_tr_b16 v[140:141], v38 offset:0
  ds_read_b64_tr_b16 v[142:143], v38 offset:512
  v_dot2_f32_bf16 v41, v147, s63, v41
  v_dot2_f32_bf16 v46, v154, s63, v46
  v_dot2_f32_bf16 v43, v147, v147, v43
  v_dot2_f32_bf16 v48, v158, s63, v48
  v_dot2_f32_bf16 v45, v151, s63, v45
  v_dot2_f32_bf16 v47, v155, s63, v47
  v_dot2_f32_bf16 v49, v159, s63, v49
  s_waitcnt lgkmcnt(7)
  v_mfma_f32_32x32x16_bf16 v[64:79], v[116:119], v[112:115], v[64:79]
  s_add_u32 m0, s57, 40960
  ds_read_b128 v[144:147], v27 offset:0
  buffer_load_dwordx4 v6, s[24:27], s61 offen offset:0 lds
  ds_read_b64_tr_b16 v[148:149], v31 offset:0
  ds_read_b64_tr_b16 v[150:151], v31 offset:512
  v_dot2_f32_bf16 v40, v112, s63, v40
  v_dot2_f32_bf16 v42, v112, v112, v42
  v_mfma_f32_32x32x16_bf16 v[80:95], v[120:123], v[112:115], v[80:95]
  s_add_u32 m0, s57, 49024
  ds_read_b64_tr_b16 v[152:153], v35 offset:0
  buffer_load_dwordx4 v6, s[24:27], s61 offen offset:128 lds
  ds_read_b64_tr_b16 v[154:155], v35 offset:512
  v_dot2_f32_bf16 v41, v113, s63, v41
  v_dot2_f32_bf16 v43, v113, v113, v43
  v_dot2_f32_bf16 v40, v114, s63, v40
  v_mfma_f32_32x32x16_bf16 v[96:111], v[124:127], v[112:115], v[96:111]
  ds_read_b64_tr_b16 v[156:157], v39 offset:0
  ds_read_b64_tr_b16 v[158:159], v39 offset:512
  v_dot2_f32_bf16 v42, v114, v114, v42
  v_dot2_f32_bf16 v41, v115, s63, v41
  v_dot2_f32_bf16 v43, v115, v115, v43
  s_waitcnt lgkmcnt(7)
  v_mfma_f32_32x32x16_bf16 v[64:79], v[132:135], v[128:131], v[64:79]
  s_add_u32 m0, s57, 57088
  ds_read_b128 v[112:115], v24 offset:32768
  buffer_load_dwordx4 v6, s[24:27], s61 offen offset:256 lds
  ds_read_b64_tr_b16 v[116:117], v28 offset:32768
  ds_read_b64_tr_b16 v[118:119], v28 offset:33280
  v_dot2_f32_bf16 v44, v132, s63, v44
  v_dot2_f32_bf16 v46, v136, s63, v46
  v_dot2_f32_bf16 v48, v140, s63, v48
  v_dot2_f32_bf16 v45, v133, s63, v45
  v_mfma_f32_32x32x16_bf16 v[80:95], v[136:139], v[128:131], v[80:95]
  s_add_u32 m0, s57, 41984
  ds_read_b64_tr_b16 v[120:121], v32 offset:32768
  buffer_load_dwordx4 v6, s[24:27], s62 offen offset:0 lds
  ds_read_b64_tr_b16 v[122:123], v32 offset:33280
  v_dot2_f32_bf16 v47, v137, s63, v47
  v_dot2_f32_bf16 v49, v141, s63, v49
  v_dot2_f32_bf16 v44, v134, s63, v44
  v_dot2_f32_bf16 v46, v138, s63, v46
  v_mfma_f32_32x32x16_bf16 v[96:111], v[140:143], v[128:131], v[96:111]
  ds_read_b64_tr_b16 v[124:125], v36 offset:32768
  ds_read_b64_tr_b16 v[126:127], v36 offset:33280
  v_dot2_f32_bf16 v48, v142, s63, v48
  v_dot2_f32_bf16 v45, v135, s63, v45
  v_dot2_f32_bf16 v47, v139, s63, v47
  v_dot2_f32_bf16 v49, v143, s63, v49
  s_waitcnt lgkmcnt(7)
  v_mfma_f32_32x32x16_bf16 v[64:79], v[148:151], v[144:147], v[64:79]
  s_add_u32 m0, s57, 50048
  ds_read_b128 v[128:131], v25 offset:32768
  buffer_load_dwordx4 v6, s[24:27], s62 offen offset:128 lds
  ds_read_b64_tr_b16 v[132:133], v29 offset:32768
  ds_read_b64_tr_b16 v[134:135], v29 offset:33280
  v_mfma_f32_32x32x16_bf16 v[80:95], v[152:155], v[144:147], v[80:95]
  s_add_u32 m0, s57, 58112
  ds_read_b64_tr_b16 v[136:137], v33 offset:32768
  buffer_load_dwordx4 v6, s[24:27], s62 offen offset:256 lds
  ds_read_b64_tr_b16 v[138:139], v33 offset:33280
  v_mfma_f32_32x32x16_bf16 v[96:111], v[156:159], v[144:147], v[96:111]
  ds_read_b64_tr_b16 v[140:141], v37 offset:32768
  ds_read_b64_tr_b16 v[142:143], v37 offset:33280
  s_waitcnt vmcnt(8)
  s_barrier
  s_mov_b32 s60, 768
  s_mov_b32 s61, 1179648
  s_mov_b32 s62, 1204224
  s_waitcnt lgkmcnt(7)
  v_mfma_f32_32x32x16_bf16 v[64:79], v[116:119], v[112:115], v[64:79]
  s_add_u32 m0, s57, 65536
  ds_read_b128 v[144:147], v26 offset:32768
  buffer_load_dwordx4 v4, s[20:23], s60 offen lds
  ds_read_b64_tr_b16 v[148:149], v30 offset:32768
  ds_read_b64_tr_b16 v[150:151], v30 offset:33280
  v_dot2_f32_bf16 v44, v116, s63, v44
  v_dot2_f32_bf16 v40, v112, s63, v40
  v_dot2_f32_bf16 v46, v120, s63, v46
  v_dot2_f32_bf16 v42, v112, v112, v42
  v_dot2_f32_bf16 v48, v124, s63, v48
  v_dot2_f32_bf16 v41, v113, s63, v41
  v_mfma_f32_32x32x16_bf16 v[80:95], v[120:123], v[112:115], v[80:95]
  s_add_u32 m0, s57, 66560
  ds_read_b64_tr_b16 v[152:153], v34 offset:32768
  buffer_load_dwordx4 v5, s[20:23], s60 offen lds
  ds_read_b64_tr_b16 v[154:155], v34 offset:33280
  v_dot2_f32_bf16 v45, v117, s63, v45
  v_dot2_f32_bf16 v43, v113, v113, v43
  v_dot2_f32_bf16 v47, v121, s63, v47
  v_dot2_f32_bf16 v40, v114, s63, v40
  v_dot2_f32_bf16 v49, v125, s63, v49
  v_dot2_f32_bf16 v42, v114, v114, v42
  v_dot2_f32_bf16 v44, v118, s63, v44
  v_mfma_f32_32x32x16_bf16 v[96:111], v[124:127], v[112:115], v[96:111]
  ds_read_b64_tr_b16 v[156:157], v38 offset:32768
  ds_read_b64_tr_b16 v[158:159], v38 offset:33280
  v_dot2_f32_bf16 v41, v115, s63, v41
  v_dot2_f32_bf16 v46, v122, s63, v46
  v_dot2_f32_bf16 v43, v115, v115, v43
  v_dot2_f32_bf16 v48, v126, s63, v48
  v_dot2_f32_bf16 v45, v119, s63, v45
  v_dot2_f32_bf16 v47, v123, s63, v47
  v_dot2_f32_bf16 v49, v127, s63, v49
  s_waitcnt lgkmcnt(7)
  v_mfma_f32_32x32x16_bf16 v[64:79], v[132:135], v[128:131], v[64:79]
  s_add_u32 m0, s57, 73728
  ds_read_b128 v[112:115], v27 offset:32768
  buffer_load_dwordx4 v6, s[24:27], s61 offen offset:0 lds
  ds_read_b64_tr_b16 v[116:117], v31 offset:32768
  ds_read_b64_tr_b16 v[118:119], v31 offset:33280
  v_dot2_f32_bf16 v40, v128, s63, v40
  v_dot2_f32_bf16 v42, v128, v128, v42
  v_mfma_f32_32x32x16_bf16 v[80:95], v[136:139], v[128:131], v[80:95]
  s_add_u32 m0, s57, 81792
  ds_read_b64_tr_b16 v[120:121], v35 offset:32768
  buffer_load_dwordx4 v6, s[24:27], s61 offen offset:128 lds
  ds_read_b64_tr_b16 v[122:123], v35 offset:33280
  v_dot2_f32_bf16 v41, v129, s63, v41
  v_dot2_f32_bf16 v43, v129, v129, v43
  v_dot2_f32_bf16 v40, v130, s63, v40
  v_mfma_f32_32x32x16_bf16 v[96:111], v[140:143], v[128:131], v[96:111]
  ds_read_b64_tr_b16 v[124:125], v39 offset:32768
  ds_read_b64_tr_b16 v[126:127], v39 offset:33280
  v_dot2_f32_bf16 v42, v130, v130, v42
  v_dot2_f32_bf16 v41, v131, s63, v41
  v_dot2_f32_bf16 v43, v131, v131, v43
  s_waitcnt lgkmcnt(7)
  v_mfma_f32_32x32x16_bf16 v[64:79], v[148:151], v[144:147], v[64:79]
  s_add_u32 m0, s57, 89856
  ds_read_b128 v[128:131], v8 offset:0
  buffer_load_dwordx4 v6, s[24:27], s61 offen offset:256 lds
  ds_read_b64_tr_b16 v[132:133], v12 offset:0
  ds_read_b64_tr_b16 v[134:135], v12 offset:512
  v_dot2_f32_bf16 v44, v148, s63, v44
  v_dot2_f32_bf16 v46, v152, s63, v46
  v_dot2_f32_bf16 v48, v156, s63, v48
  v_dot2_f32_bf16 v45, v149, s63, v45
  v_mfma_f32_32x32x16_bf16 v[80:95], v[152:155], v[144:147], v[80:95]
  s_add_u32 m0, s57, 74752
  ds_read_b64_tr_b16 v[136:137], v16 offset:0
  buffer_load_dwordx4 v6, s[24:27], s62 offen offset:0 lds
  ds_read_b64_tr_b16 v[138:139], v16 offset:512
  v_dot2_f32_bf16 v47, v153, s63, v47
  v_dot2_f32_bf16 v49, v157, s63, v49
  v_dot2_f32_bf16 v44, v150, s63, v44
  v_dot2_f32_bf16 v46, v154, s63, v46
  v_mfma_f32_32x32x16_bf16 v[96:111], v[156:159], v[144:147], v[96:111]
  ds_read_b64_tr_b16 v[140:141], v20 offset:0
  ds_read_b64_tr_b16 v[142:143], v20 offset:512
  v_dot2_f32_bf16 v48, v158, s63, v48
  v_dot2_f32_bf16 v45, v151, s63, v45
  v_dot2_f32_bf16 v47, v155, s63, v47
  v_dot2_f32_bf16 v49, v159, s63, v49
  s_waitcnt lgkmcnt(7)
  v_mfma_f32_32x32x16_bf16 v[64:79], v[116:119], v[112:115], v[64:79]
  s_add_u32 m0, s57, 82816
  ds_read_b128 v[144:147], v9 offset:0
  buffer_load_dwordx4 v6, s[24:27], s62 offen offset:128 lds
  ds_read_b64_tr_b16 v[148:149], v13 offset:0
  ds_read_b64_tr_b16 v[150:151], v13 offset:512
  v_mfma_f32_32x32x16_bf16 v[80:95], v[120:123], v[112:115], v[80:95]
  s_add_u32 m0, s57, 90880
  ds_read_b64_tr_b16 v[152:153], v17 offset:0
  buffer_load_dwordx4 v6, s[24:27], s62 offen offset:256 lds
  ds_read_b64_tr_b16 v[154:155], v17 offset:512
  v_mfma_f32_32x32x16_bf16 v[96:111], v[124:127], v[112:115], v[96:111]
  ds_read_b64_tr_b16 v[156:157], v21 offset:0
  ds_read_b64_tr_b16 v[158:159], v21 offset:512
  s_waitcnt vmcnt(8)
  s_barrier
  s_mov_b32 s60, 896
  s_mov_b32 s61, 1376256
  s_mov_b32 s62, 1400832
  s_waitcnt lgkmcnt(7)
  v_mfma_f32_32x32x16_bf16 v[64:79], v[132:135], v[128:131], v[64:79]
  s_add_u32 m0, s57, 98304
  ds_read_b128 v[112:115], v10 offset:0
  buffer_load_dwordx4 v4, s[20:23], s60 offen lds
  ds_read_b64_tr_b16 v[116:117], v14 offset:0
  ds_read_b64_tr_b16 v[118:119], v14 offset:512
  v_dot2_f32_bf16 v44, v132, s63, v44
  v_dot2_f32_bf16 v40, v128, s63, v40
  v_dot2_f32_bf16 v46, v136, s63, v46
  v_dot2_f32_bf16 v42, v128, v128, v42
  v_dot2_f32_bf16 v48, v140, s63, v48
  v_dot2_f32_bf16 v41, v129, s63, v41
  v_mfma_f32_32x32x16_bf16 v[80:95], v[136:139], v[128:131], v[80:95]
  s_add_u32 m0, s57, 99328
  ds_read_b64_tr_b16 v[120:121], v18 offset:0
  buffer_load_dwordx4 v5, s[20:23], s60 offen lds
  ds_read_b64_tr_b16 v[122:123], v18 offset:512
  v_dot2_f32_bf16 v45, v133, s63, v45
  v_dot2_f32_bf16 v43, v129, v129, v43
  v_dot2_f32_bf16 v47, v137, s63, v47
  v_dot2_f32_bf16 v40, v130, s63, v40
  v_dot2_f32_bf16 v49, v141, s63, v49
  v_dot2_f32_bf16 v42, v130, v130, v42
  v_dot2_f32_bf16 v44, v134, s63, v44
  v_mfma_f32_32x32x16_bf16 v[96:111], v[140:143], v[128:131], v[96:111]
  ds_read_b64_tr_b16 v[124:125], v22 offset:0
  ds_read_b64_tr_b16 v[126:127], v22 offset:512
  v_dot2_f32_bf16 v41, v131, s63, v41
  v_dot2_f32_bf16 v46, v138, s63, v46
  v_dot2_f32_bf16 v43, v131, v131, v43
  v_dot2_f32_bf16 v48, v142, s63, v48
  v_dot2_f32_bf16 v45, v135, s63, v45
  v_dot2_f32_bf16 v47, v139, s63, v47
  v_dot2_f32_bf16 v49, v143, s63, v49
  s_waitcnt lgkmcnt(7)
  v_mfma_f32_32x32x16_bf16 v[64:79], v[148:151], v[144:147], v[64:79]
  s_add_u32 m0, s57, 106496
  ds_read_b128 v[128:131], v11 offset:0
  buffer_load_dwordx4 v6, s[24:27], s61 offen offset:0 lds
  ds_read_b64_tr_b16 v[132:133], v15 offset:0
  ds_read_b64_tr_b16 v[134:135], v15 offset:512
  v_dot2_f32_bf16 v40, v144, s63, v40
  v_dot2_f32_bf16 v42, v144, v144, v42
  v_mfma_f32_32x32x16_bf16 v[80:95], v[152:155], v[144:147], v[80:95]
  s_add_u32 m0, s57, 114560
  ds_read_b64_tr_b16 v[136:137], v19 offset:0
  buffer_load_dwordx4 v6, s[24:27], s61 offen offset:128 lds
  ds_read_b64_tr_b16 v[138:139], v19 offset:512
  v_dot2_f32_bf16 v41, v145, s63, v41
  v_dot2_f32_bf16 v43, v145, v145, v43
  v_dot2_f32_bf16 v40, v146, s63, v40
  v_mfma_f32_32x32x16_bf16 v[96:111], v[156:159], v[144:147], v[96:111]
  ds_read_b64_tr_b16 v[140:141], v23 offset:0
  ds_read_b64_tr_b16 v[142:143], v23 offset:512
  v_dot2_f32_bf16 v42, v146, v146, v42
  v_dot2_f32_bf16 v41, v147, s63, v41
  v_dot2_f32_bf16 v43, v147, v147, v43
  s_waitcnt lgkmcnt(7)
  v_mfma_f32_32x32x16_bf16 v[64:79], v[116:119], v[112:115], v[64:79]
  s_add_u32 m0, s57, 122624
  ds_read_b128 v[144:147], v8 offset:32768
  buffer_load_dwordx4 v6, s[24:27], s61 offen offset:256 lds
  ds_read_b64_tr_b16 v[148:149], v12 offset:32768
  ds_read_b64_tr_b16 v[150:151], v12 offset:33280
  v_dot2_f32_bf16 v44, v116, s63, v44
  v_dot2_f32_bf16 v46, v120, s63, v46
  v_dot2_f32_bf16 v48, v124, s63, v48
  v_dot2_f32_bf16 v45, v117, s63, v45
  v_mfma_f32_32x32x16_bf16 v[80:95], v[120:123], v[112:115], v[80:95]
  s_add_u32 m0, s57, 107520
  ds_read_b64_tr_b16 v[152:153], v16 offset:32768
  buffer_load_dwordx4 v6, s[24:27], s62 offen offset:0 lds
  ds_read_b64_tr_b16 v[154:155], v16 offset:33280
  v_dot2_f32_bf16 v47, v121, s63, v47
  v_dot2_f32_bf16 v49, v125, s63, v49
  v_dot2_f32_bf16 v44, v118, s63, v44
  v_dot2_f32_bf16 v46, v122, s63, v46
  v_mfma_f32_32x32x16_bf16 v[96:111], v[124:127], v[112:115], v[96:111]
  ds_read_b64_tr_b16 v[156:157], v20 offset:32768
  ds_read_b64_tr_b16 v[158:159], v20 offset:33280
  v_dot2_f32_bf16 v48, v126, s63, v48
  v_dot2_f32_bf16 v45, v119, s63, v45
  v_dot2_f32_bf16 v47, v123, s63, v47
  v_dot2_f32_bf16 v49, v127, s63, v49
  s_waitcnt lgkmcnt(7)
  v_mfma_f32_32x32x16_bf16 v[64:79], v[132:135], v[128:131], v[64:79]
  s_add_u32 m0, s57, 115584
  ds_read_b128 v[112:115], v9 offset:32768
  buffer_load_dwordx4 v6, s[24:27], s62 offen offset:128 lds
  ds_read_b64_tr_b16 v[116:117], v13 offset:32768
  ds_read_b64_tr_b16 v[118:119], v13 offset:33280
  v_mfma_f32_32x32x16_bf16 v[80:95], v[136:139], v[128:131], v[80:95]
  s_add_u32 m0, s57, 123648
  ds_read_b64_tr_b16 v[120:121], v17 offset:32768
  buffer_load_dwordx4 v6, s[24:27], s62 offen offset:256 lds
  ds_read_b64_tr_b16 v[122:123], v17 offset:33280
  v_mfma_f32_32x32x16_bf16 v[96:111], v[140:143], v[128:131], v[96:111]
  ds_read_b64_tr_b16 v[124:125], v21 offset:32768
  ds_read_b64_tr_b16 v[126:127], v21 offset:33280
  s_waitcnt vmcnt(8)
  s_barrier
  s_mov_b32 s60, 1024
  s_mov_b32 s61, 1572864
  s_mov_b32 s62, 1597440
  s_waitcnt lgkmcnt(7)
  v_mfma_f32_32x32x16_bf16 v[64:79], v[148:151], v[144:147], v[64:79]
  s_add_u32 m0, s57, 0
  ds_read_b128 v[128:131], v10 offset:32768
  buffer_load_dwordx4 v4, s[20:23], s60 offen lds
  ds_read_b64_tr_b16 v[132:133], v14 offset:32768
  ds_read_b64_tr_b16 v[134:135], v14 offset:33280
  v_dot2_f32_bf16 v44, v148, s63, v44
  v_dot2_f32_bf16 v40, v144, s63, v40
  v_dot2_f32_bf16 v46, v152, s63, v46
  v_dot2_f32_bf16 v42, v144, v144, v42
  v_dot2_f32_bf16 v48, v156, s63, v48
  v_dot2_f32_bf16 v41, v145, s63, v41
  v_mfma_f32_32x32x16_bf16 v[80:95], v[152:155], v[144:147], v[80:95]
  s_add_u32 m0, s57, 1024
  ds_read_b64_tr_b16 v[136:137], v18 offset:32768
  buffer_load_dwordx4 v5, s[20:23], s60 offen lds
  ds_read_b64_tr_b16 v[138:139], v18 offset:33280
  v_dot2_f32_bf16 v45, v149, s63, v45
  v_dot2_f32_bf16 v43, v145, v145, v43
  v_dot2_f32_bf16 v47, v153, s63, v47
  v_dot2_f32_bf16 v40, v146, s63, v40
  v_dot2_f32_bf16 v49, v157, s63, v49
  v_dot2_f32_bf16 v42, v146, v146, v42
  v_dot2_f32_bf16 v44, v150, s63, v44
  v_mfma_f32_32x32x16_bf16 v[96:111], v[156:159], v[144:147], v[96:111]
  ds_read_b64_tr_b16 v[140:141], v22 offset:32768
  ds_read_b64_tr_b16 v[142:143], v22 offset:33280
  v_dot2_f32_bf16 v41, v147, s63, v41
  v_dot2_f32_bf16 v46, v154, s63, v46
  v_dot2_f32_bf16 v43, v147, v147, v43
  v_dot2_f32_bf16 v48, v158, s63, v48
  v_dot2_f32_bf16 v45, v151, s63, v45
  v_dot2_f32_bf16 v47, v155, s63, v47
  v_dot2_f32_bf16 v49, v159, s63, v49
  s_waitcnt lgkmcnt(7)
  v_mfma_f32_32x32x16_bf16 v[64:79], v[116:119], v[112:115], v[64:79]
  s_add_u32 m0, s57, 8192
  ds_read_b128 v[144:147], v11 offset:32768
  buffer_load_dwordx4 v6, s[24:27], s61 offen offset:0 lds
  ds_read_b64_tr_b16 v[148:149], v15 offset:32768
  ds_read_b64_tr_b16 v[150:151], v15 offset:33280
  v_dot2_f32_bf16 v40, v112, s63, v40
  v_dot2_f32_bf16 v42, v112, v112, v42
  v_mfma_f32_32x32x16_bf16 v[80:95], v[120:123], v[112:115], v[80:95]
  s_add_u32 m0, s57, 16256
  ds_read_b64_tr_b16 v[152:153], v19 offset:32768
  buffer_load_dwordx4 v6, s[24:27], s61 offen offset:128 lds
  ds_read_b64_tr_b16 v[154:155], v19 offset:33280
  v_dot2_f32_bf16 v41, v113, s63, v41
  v_dot2_f32_bf16 v43, v113, v113, v43
  v_dot2_f32_bf16 v40, v114, s63, v40
  v_mfma_f32_32x32x16_bf16 v[96:111], v[124:127], v[112:115], v[96:111]
  ds_read_b64_tr_b16 v[156:157], v23 offset:32768
  ds_read_b64_tr_b16 v[158:159], v23 offset:33280
  v_dot2_f32_bf16 v42, v114, v114, v42
  v_dot2_f32_bf16 v41, v115, s63, v41
  v_dot2_f32_bf16 v43, v115, v115, v43
  s_waitcnt lgkmcnt(7)
  v_mfma_f32_32x32x16_bf16 v[64:79], v[132:135], v[128:131], v[64:79]
  s_add_u32 m0, s57, 24320
  ds_read_b128 v[112:115], v24 offset:0
  buffer_load_dwordx4 v6, s[24:27], s61 offen offset:256 lds
  ds_read_b64_tr_b16 v[116:117], v28 offset:0
  ds_read_b64_tr_b16 v[118:119], v28 offset:512
  v_dot2_f32_bf16 v44, v132, s63, v44
  v_dot2_f32_bf16 v46, v136, s63, v46
  v_dot2_f32_bf16 v48, v140, s63, v48
  v_dot2_f32_bf16 v45, v133, s63, v45
  v_mfma_f32_32x32x16_bf16 v[80:95], v[136:139], v[128:131], v[80:95]
  s_add_u32 m0, s57, 9216
  ds_read_b64_tr_b16 v[120:121], v32 offset:0
  buffer_load_dwordx4 v6, s[24:27], s62 offen offset:0 lds
  ds_read_b64_tr_b16 v[122:123], v32 offset:512
  v_dot2_f32_bf16 v47, v137, s63, v47
  v_dot2_f32_bf16 v49, v141, s63, v49
  v_dot2_f32_bf16 v44, v134, s63, v44
  v_dot2_f32_bf16 v46, v138, s63, v46
  v_mfma_f32_32x32x16_bf16 v[96:111], v[140:143], v[128:131], v[96:111]
  ds_read_b64_tr_b16 v[124:125], v36 offset:0
  ds_read_b64_tr_b16 v[126:127], v36 offset:512
  v_dot2_f32_bf16 v48, v142, s63, v48
  v_dot2_f32_bf16 v45, v135, s63, v45
  v_dot2_f32_bf16 v47, v139, s63, v47
  v_dot2_f32_bf16 v49, v143, s63, v49
  s_waitcnt lgkmcnt(7)
  v_mfma_f32_32x32x16_bf16 v[64:79], v[148:151], v[144:147], v[64:79]
  s_add_u32 m0, s57, 17280
  ds_read_b128 v[128:131], v25 offset:0
  buffer_load_dwordx4 v6, s[24:27], s62 offen offset:128 lds
  ds_read_b64_tr_b16 v[132:133], v29 offset:0
  ds_read_b64_tr_b16 v[134:135], v29 offset:512
  v_mfma_f32_32x32x16_bf16 v[80:95], v[152:155], v[144:147], v[80:95]
  s_add_u32 m0, s57, 25344
  ds_read_b64_tr_b16 v[136:137], v33 offset:0
  buffer_load_dwordx4 v6, s[24:27], s62 offen offset:256 lds
  ds_read_b64_tr_b16 v[138:139], v33 offset:512
  v_mfma_f32_32x32x16_bf16 v[96:111], v[156:159], v[144:147], v[96:111]
  ds_read_b64_tr_b16 v[140:141], v37 offset:0
  ds_read_b64_tr_b16 v[142:143], v37 offset:512
  s_waitcnt vmcnt(8)
  s_barrier
  s_mov_b32 s60, 1152
  s_mov_b32 s61, 1769472
  s_mov_b32 s62, 1794048
  s_waitcnt lgkmcnt(7)
  v_mfma_f32_32x32x16_bf16 v[64:79], v[116:119], v[112:115], v[64:79]
  s_add_u32 m0, s57, 32768
  ds_read_b128 v[144:147], v26 offset:0
  buffer_load_dwordx4 v4, s[20:23], s60 offen lds
  ds_read_b64_tr_b16 v[148:149], v30 offset:0
  ds_read_b64_tr_b16 v[150:151], v30 offset:512
  v_dot2_f32_bf16 v44, v116, s63, v44
  v_dot2_f32_bf16 v40, v112, s63, v40
  v_dot2_f32_bf16 v46, v120, s63, v46
  v_dot2_f32_bf16 v42, v112, v112, v42
  v_dot2_f32_bf16 v48, v124, s63, v48
  v_dot2_f32_bf16 v41, v113, s63, v41
  v_mfma_f32_32x32x16_bf16 v[80:95], v[120:123], v[112:115], v[80:95]
  s_add_u32 m0, s57, 33792
  ds_read_b64_tr_b16 v[152:153], v34 offset:0
  buffer_load_dwordx4 v5, s[20:23], s60 offen lds
  ds_read_b64_tr_b16 v[154:155], v34 offset:512
  v_dot2_f32_bf16 v45, v117, s63, v45
  v_dot2_f32_bf16 v43, v113, v113, v43
  v_dot2_f32_bf16 v47, v121, s63, v47
  v_dot2_f32_bf16 v40, v114, s63, v40
  v_dot2_f32_bf16 v49, v125, s63, v49
  v_dot2_f32_bf16 v42, v114, v114, v42
  v_dot2_f32_bf16 v44, v118, s63, v44
  v_mfma_f32_32x32x16_bf16 v[96:111], v[124:127], v[112:115], v[96:111]
  ds_read_b64_tr_b16 v[156:157], v38 offset:0
  ds_read_b64_tr_b16 v[158:159], v38 offset:512
  v_dot2_f32_bf16 v41, v115, s63, v41
  v_dot2_f32_bf16 v46, v122, s63, v46
  v_dot2_f32_bf16 v43, v115, v115, v43
  v_dot2_f32_bf16 v48, v126, s63, v48
  v_dot2_f32_bf16 v45, v119, s63, v45
  v_dot2_f32_bf16 v47, v123, s63, v47
  v_dot2_f32_bf16 v49, v127, s63, v49
  s_waitcnt lgkmcnt(7)
  v_mfma_f32_32x32x16_bf16 v[64:79], v[132:135], v[128:131], v[64:79]
  s_add_u32 m0, s57, 40960
  ds_read_b128 v[112:115], v27 offset:0
  buffer_load_dwordx4 v6, s[24:27], s61 offen offset:0 lds
  ds_read_b64_tr_b16 v[116:117], v31 offset:0
  ds_read_b64_tr_b16 v[118:119], v31 offset:512
  v_dot2_f32_bf16 v40, v128, s63, v40
  v_dot2_f32_bf16 v42, v128, v128, v42
  v_mfma_f32_32x32x16_bf16 v[80:95], v[136:139], v[128:131], v[80:95]
  s_add_u32 m0, s57, 49024
  ds_read_b64_tr_b16 v[120:121], v35 offset:0
  buffer_load_dwordx4 v6, s[24:27], s61 offen offset:128 lds
  ds_read_b64_tr_b16 v[122:123], v35 offset:512
  v_dot2_f32_bf16 v41, v129, s63, v41
  v_dot2_f32_bf16 v43, v129, v129, v43
  v_dot2_f32_bf16 v40, v130, s63, v40
  v_mfma_f32_32x32x16_bf16 v[96:111], v[140:143], v[128:131], v[96:111]
  ds_read_b64_tr_b16 v[124:125], v39 offset:0
  ds_read_b64_tr_b16 v[126:127], v39 offset:512
  v_dot2_f32_bf16 v42, v130, v130, v42
  v_dot2_f32_bf16 v41, v131, s63, v41
  v_dot2_f32_bf16 v43, v131, v131, v43
  s_waitcnt lgkmcnt(7)
  v_mfma_f32_32x32x16_bf16 v[64:79], v[148:151], v[144:147], v[64:79]
  s_add_u32 m0, s57, 57088
  ds_read_b128 v[128:131], v24 offset:32768
  buffer_load_dwordx4 v6, s[24:27], s61 offen offset:256 lds
  ds_read_b64_tr_b16 v[132:133], v28 offset:32768
  ds_read_b64_tr_b16 v[134:135], v28 offset:33280
  v_dot2_f32_bf16 v44, v148, s63, v44
  v_dot2_f32_bf16 v46, v152, s63, v46
  v_dot2_f32_bf16 v48, v156, s63, v48
  v_dot2_f32_bf16 v45, v149, s63, v45
  v_mfma_f32_32x32x16_bf16 v[80:95], v[152:155], v[144:147], v[80:95]
  s_add_u32 m0, s57, 41984
  ds_read_b64_tr_b16 v[136:137], v32 offset:32768
  buffer_load_dwordx4 v6, s[24:27], s62 offen offset:0 lds
  ds_read_b64_tr_b16 v[138:139], v32 offset:33280
  v_dot2_f32_bf16 v47, v153, s63, v47
  v_dot2_f32_bf16 v49, v157, s63, v49
  v_dot2_f32_bf16 v44, v150, s63, v44
  v_dot2_f32_bf16 v46, v154, s63, v46
  v_mfma_f32_32x32x16_bf16 v[96:111], v[156:159], v[144:147], v[96:111]
  ds_read_b64_tr_b16 v[140:141], v36 offset:32768
  ds_read_b64_tr_b16 v[142:143], v36 offset:33280
  v_dot2_f32_bf16 v48, v158, s63, v48
  v_dot2_f32_bf16 v45, v151, s63, v45
  v_dot2_f32_bf16 v47, v155, s63, v47
  v_dot2_f32_bf16 v49, v159, s63, v49
  s_waitcnt lgkmcnt(7)
  v_mfma_f32_32x32x16_bf16 v[64:79], v[116:119], v[112:115], v[64:79]
  s_add_u32 m0, s57, 50048
  ds_read_b128 v[144:147], v25 offset:32768
  buffer_load_dwordx4 v6, s[24:27], s62 offen offset:128 lds
  ds_read_b64_tr_b16 v[148:149], v29 offset:32768
  ds_read_b64_tr_b16 v[150:151], v29 offset:33280
  v_mfma_f32_32x32x16_bf16 v[80:95], v[120:123], v[112:115], v[80:95]
  s_add_u32 m0, s57, 58112
  ds_read_b64_tr_b16 v[152:153], v33 offset:32768
  buffer_load_dwordx4 v6, s[24:27], s62 offen offset:256 lds
  ds_read_b64_tr_b16 v[154:155], v33 offset:33280
  v_mfma_f32_32x32x16_bf16 v[96:111], v[124:127], v[112:115], v[96:111]
  ds_read_b64_tr_b16 v[156:157], v37 offset:32768
  ds_read_b64_tr_b16 v[158:159], v37 offset:33280
  s_waitcnt vmcnt(8)
  s_barrier
  s_waitcnt lgkmcnt(7)
  v_mfma_f32_32x32x16_bf16 v[64:79], v[132:135], v[128:131], v[64:79]
  ds_read_b128 v[112:115], v26 offset:32768
  ds_read_b64_tr_b16 v[116:117], v30 offset:32768
  ds_read_b64_tr_b16 v[118:119], v30 offset:33280
  v_dot2_f32_bf16 v44, v132, s63, v44
  v_dot2_f32_bf16 v40, v128, s63, v40
  v_dot2_f32_bf16 v46, v136, s63, v46
  v_dot2_f32_bf16 v42, v128, v128, v42
  v_dot2_f32_bf16 v48, v140, s63, v48
  v_dot2_f32_bf16 v41, v129, s63, v41
  v_mfma_f32_32x32x16_bf16 v[80:95], v[136:139], v[128:131], v[80:95]
  ds_read_b64_tr_b16 v[120:121], v34 offset:32768
  ds_read_b64_tr_b16 v[122:123], v34 offset:33280
  v_dot2_f32_bf16 v45, v133, s63, v45
  v_dot2_f32_bf16 v43, v129, v129, v43
  v_dot2_f32_bf16 v47, v137, s63, v47
  v_dot2_f32_bf16 v40, v130, s63, v40
  v_dot2_f32_bf16 v49, v141, s63, v49
  v_dot2_f32_bf16 v42, v130, v130, v42
  v_dot2_f32_bf16 v44, v134, s63, v44
  v_mfma_f32_32x32x16_bf16 v[96:111], v[140:143], v[128:131], v[96:111]
  ds_read_b64_tr_b16 v[124:125], v38 offset:32768
  ds_read_b64_tr_b16 v[126:127], v38 offset:33280
  v_dot2_f32_bf16 v41, v131, s63, v41
  v_dot2_f32_bf16 v46, v138, s63, v46
  v_dot2_f32_bf16 v43, v131, v131, v43
  v_dot2_f32_bf16 v48, v142, s63, v48
  v_dot2_f32_bf16 v45, v135, s63, v45
  v_dot2_f32_bf16 v47, v139, s63, v47
  v_dot2_f32_bf16 v49, v143, s63, v49
  s_waitcnt lgkmcnt(7)
  v_mfma_f32_32x32x16_bf16 v[64:79], v[148:151], v[144:147], v[64:79]
  ds_read_b128 v[128:131], v27 offset:32768
  ds_read_b64_tr_b16 v[132:133], v31 offset:32768
  ds_read_b64_tr_b16 v[134:135], v31 offset:33280
  v_dot2_f32_bf16 v40, v144, s63, v40
  v_dot2_f32_bf16 v42, v144, v144, v42
  v_mfma_f32_32x32x16_bf16 v[80:95], v[152:155], v[144:147], v[80:95]
  ds_read_b64_tr_b16 v[136:137], v35 offset:32768
  ds_read_b64_tr_b16 v[138:139], v35 offset:33280
  v_dot2_f32_bf16 v41, v145, s63, v41
  v_dot2_f32_bf16 v43, v145, v145, v43
  v_dot2_f32_bf16 v40, v146, s63, v40
  v_mfma_f32_32x32x16_bf16 v[96:111], v[156:159], v[144:147], v[96:111]
  ds_read_b64_tr_b16 v[140:141], v39 offset:32768
  ds_read_b64_tr_b16 v[142:143], v39 offset:33280
  v_dot2_f32_bf16 v42, v146, v146, v42
  v_dot2_f32_bf16 v41, v147, s63, v41
  v_dot2_f32_bf16 v43, v147, v147, v43
  s_waitcnt lgkmcnt(7)
  v_mfma_f32_32x32x16_bf16 v[64:79], v[116:119], v[112:115], v[64:79]
  ds_read_b128 v[144:147], v8 offset:0
  ds_read_b64_tr_b16 v[148:149], v12 offset:0
  ds_read_b64_tr_b16 v[150:151], v12 offset:512
  v_dot2_f32_bf16 v44, v116, s63, v44
  v_dot2_f32_bf16 v46, v120, s63, v46
  v_dot2_f32_bf16 v48, v124, s63, v48
  v_dot2_f32_bf16 v45, v117, s63, v45
  v_mfma_f32_32x32x16_bf16 v[80:95], v[120:123], v[112:115], v[80:95]
  ds_read_b64_tr_b16 v[152:153], v16 offset:0
  ds_read_b64_tr_b16 v[154:155], v16 offset:512
  v_dot2_f32_bf16 v47, v121, s63, v47
  v_dot2_f32_bf16 v49, v125, s63, v49
  v_dot2_f32_bf16 v44, v118, s63, v44
  v_dot2_f32_bf16 v46, v122, s63, v46
  v_mfma_f32_32x32x16_bf16 v[96:111], v[124:127], v[112:115], v[96:111]
  ds_read_b64_tr_b16 v[156:157], v20 offset:0
  ds_read_b64_tr_b16 v[158:159], v20 offset:512
  v_dot2_f32_bf16 v48, v126, s63, v48
  v_dot2_f32_bf16 v45, v119, s63, v45
  v_dot2_f32_bf16 v47, v123, s63, v47
  v_dot2_f32_bf16 v49, v127, s63, v49
  s_waitcnt lgkmcnt(7)
  v_mfma_f32_32x32x16_bf16 v[64:79], v[132:135], v[128:131], v[64:79]
  ds_read_b128 v[112:115], v9 offset:0
  ds_read_b64_tr_b16 v[116:117], v13 offset:0
  ds_read_b64_tr_b16 v[118:119], v13 offset:512
  v_mfma_f32_32x32x16_bf16 v[80:95], v[136:139], v[128:131], v[80:95]
  ds_read_b64_tr_b16 v[120:121], v17 offset:0
  ds_read_b64_tr_b16 v[122:123], v17 offset:512
  v_mfma_f32_32x32x16_bf16 v[96:111], v[140:143], v[128:131], v[96:111]
  ds_read_b64_tr_b16 v[124:125], v21 offset:0
  ds_read_b64_tr_b16 v[126:127], v21 offset:512
  s_waitcnt vmcnt(0)
  s_barrier
  s_waitcnt lgkmcnt(7)
  v_mfma_f32_32x32x16_bf16 v[64:79], v[148:151], v[144:147], v[64:79]
  ds_read_b128 v[128:131], v10 offset:0
  ds_read_b64_tr_b16 v[132:133], v14 offset:0
  ds_read_b64_tr_b16 v[134:135], v14 offset:512
  v_dot2_f32_bf16 v44, v148, s63, v44
  v_dot2_f32_bf16 v40, v144, s63, v40
  v_dot2_f32_bf16 v46, v152, s63, v46
  v_dot2_f32_bf16 v42, v144, v144, v42
  v_dot2_f32_bf16 v48, v156, s63, v48
  v_dot2_f32_bf16 v41, v145, s63, v41
  v_mfma_f32_32x32x16_bf16 v[80:95], v[152:155], v[144:147], v[80:95]
  ds_read_b64_tr_b16 v[136:137], v18 offset:0
  ds_read_b64_tr_b16 v[138:139], v18 offset:512
  v_dot2_f32_bf16 v45, v149, s63, v45
  v_dot2_f32_bf16 v43, v145, v145, v43
  v_dot2_f32_bf16 v47, v153, s63, v47
  v_dot2_f32_bf16 v40, v146, s63, v40
  v_dot2_f32_bf16 v49, v157, s63, v49
  v_dot2_f32_bf16 v42, v146, v146, v42
  v_dot2_f32_bf16 v44, v150, s63, v44
  v_mfma_f32_32x32x16_bf16 v[96:111], v[156:159], v[144:147], v[96:111]
  ds_read_b64_tr_b16 v[140:141], v22 offset:0
  ds_read_b64_tr_b16 v[142:143], v22 offset:512
  v_dot2_f32_bf16 v41, v147, s63, v41
  v_dot2_f32_bf16 v46, v154, s63, v46
  v_dot2_f32_bf16 v43, v147, v147, v43
  v_dot2_f32_bf16 v48, v158, s63, v48
  v_dot2_f32_bf16 v45, v151, s63, v45
  v_dot2_f32_bf16 v47, v155, s63, v47
  v_dot2_f32_bf16 v49, v159, s63, v49
  s_waitcnt lgkmcnt(7)
  v_mfma_f32_32x32x16_bf16 v[64:79], v[116:119], v[112:115], v[64:79]
  ds_read_b128 v[144:147], v11 offset:0
  ds_read_b64_tr_b16 v[148:149], v15 offset:0
  ds_read_b64_tr_b16 v[150:151], v15 offset:512
  v_dot2_f32_bf16 v40, v112, s63, v40
  v_dot2_f32_bf16 v42, v112, v112, v42
  v_mfma_f32_32x32x16_bf16 v[80:95], v[120:123], v[112:115], v[80:95]
  ds_read_b64_tr_b16 v[152:153], v19 offset:0
  ds_read_b64_tr_b16 v[154:155], v19 offset:512
  v_dot2_f32_bf16 v41, v113, s63, v41
  v_dot2_f32_bf16 v43, v113, v113, v43
  v_dot2_f32_bf16 v40, v114, s63, v40
  v_mfma_f32_32x32x16_bf16 v[96:111], v[124:127], v[112:115], v[96:111]
  ds_read_b64_tr_b16 v[156:157], v23 offset:0
  ds_read_b64_tr_b16 v[158:159], v23 offset:512
  v_dot2_f32_bf16 v42, v114, v114, v42
  v_dot2_f32_bf16 v41, v115, s63, v41
  v_dot2_f32_bf16 v43, v115, v115, v43
  s_waitcnt lgkmcnt(7)
  v_mfma_f32_32x32x16_bf16 v[64:79], v[132:135], v[128:131], v[64:79]
  ds_read_b128 v[112:115], v8 offset:32768
  ds_read_b64_tr_b16 v[116:117], v12 offset:32768
  ds_read_b64_tr_b16 v[118:119], v12 offset:33280
  v_dot2_f32_bf16 v44, v132, s63, v44
  v_dot2_f32_bf16 v46, v136, s63, v46
  v_dot2_f32_bf16 v48, v140, s63, v48
  v_dot2_f32_bf16 v45, v133, s63, v45
  v_mfma_f32_32x32x16_bf16 v[80:95], v[136:139], v[128:131], v[80:95]
  ds_read_b64_tr_b16 v[120:121], v16 offset:32768
  ds_read_b64_tr_b16 v[122:123], v16 offset:33280
  v_dot2_f32_bf16 v47, v137, s63, v47
  v_dot2_f32_bf16 v49, v141, s63, v49
  v_dot2_f32_bf16 v44, v134, s63, v44
  v_dot2_f32_bf16 v46, v138, s63, v46
  v_mfma_f32_32x32x16_bf16 v[96:111], v[140:143], v[128:131], v[96:111]
  ds_read_b64_tr_b16 v[124:125], v20 offset:32768
  ds_read_b64_tr_b16 v[126:127], v20 offset:33280
  v_dot2_f32_bf16 v48, v142, s63, v48
  v_dot2_f32_bf16 v45, v135, s63, v45
  v_dot2_f32_bf16 v47, v139, s63, v47
  v_dot2_f32_bf16 v49, v143, s63, v49
  s_waitcnt lgkmcnt(7)
  v_mfma_f32_32x32x16_bf16 v[64:79], v[148:151], v[144:147], v[64:79]
  ds_read_b128 v[128:131], v9 offset:32768
  ds_read_b64_tr_b16 v[132:133], v13 offset:32768
  ds_read_b64_tr_b16 v[134:135], v13 offset:33280
  v_mfma_f32_32x32x16_bf16 v[80:95], v[152:155], v[144:147], v[80:95]
  ds_read_b64_tr_b16 v[136:137], v17 offset:32768
  ds_read_b64_tr_b16 v[138:139], v17 offset:33280
  v_mfma_f32_32x32x16_bf16 v[96:111], v[156:159], v[144:147], v[96:111]
  ds_read_b64_tr_b16 v[140:141], v21 offset:32768
  ds_read_b64_tr_b16 v[142:143], v21 offset:33280
  s_waitcnt lgkmcnt(7)
  v_mfma_f32_32x32x16_bf16 v[64:79], v[116:119], v[112:115], v[64:79]
  ds_read_b128 v[144:147], v10 offset:32768
  ds_read_b64_tr_b16 v[148:149], v14 offset:32768
  ds_read_b64_tr_b16 v[150:151], v14 offset:33280
  v_dot2_f32_bf16 v44, v116, s63, v44
  v_dot2_f32_bf16 v40, v112, s63, v40
  v_dot2_f32_bf16 v46, v120, s63, v46
  v_dot2_f32_bf16 v42, v112, v112, v42
  v_dot2_f32_bf16 v48, v124, s63, v48
  v_dot2_f32_bf16 v41, v113, s63, v41
  v_mfma_f32_32x32x16_bf16 v[80:95], v[120:123], v[112:115], v[80:95]
  ds_read_b64_tr_b16 v[152:153], v18 offset:32768
  ds_read_b64_tr_b16 v[154:155], v18 offset:33280
  v_dot2_f32_bf16 v45, v117, s63, v45
  v_dot2_f32_bf16 v43, v113, v113, v43
  v_dot2_f32_bf16 v47, v121, s63, v47
  v_dot2_f32_bf16 v40, v114, s63, v40
  v_dot2_f32_bf16 v49, v125, s63, v49
  v_dot2_f32_bf16 v42, v114, v114, v42
  v_dot2_f32_bf16 v44, v118, s63, v44
  v_mfma_f32_32x32x16_bf16 v[96:111], v[124:127], v[112:115], v[96:111]
  ds_read_b64_tr_b16 v[156:157], v22 offset:32768
  ds_read_b64_tr_b16 v[158:159], v22 offset:33280
  v_dot2_f32_bf16 v41, v115, s63, v41
  v_dot2_f32_bf16 v46, v122, s63, v46
  v_dot2_f32_bf16 v43, v115, v115, v43
  v_dot2_f32_bf16 v48, v126, s63, v48
  v_dot2_f32_bf16 v45, v119, s63, v45
  v_dot2_f32_bf16 v47, v123, s63, v47
  v_dot2_f32_bf16 v49, v127, s63, v49
  s_waitcnt lgkmcnt(7)
  v_mfma_f32_32x32x16_bf16 v[64:79], v[132:135], v[128:131], v[64:79]
  ds_read_b128 v[112:115], v11 offset:32768
  ds_read_b64_tr_b16 v[116:117], v15 offset:32768
  ds_read_b64_tr_b16 v[118:119], v15 offset:33280
  v_dot2_f32_bf16 v40, v128, s63, v40
  v_dot2_f32_bf16 v42, v128, v128, v42
  v_mfma_f32_32x32x16_bf16 v[80:95], v[136:139], v[128:131], v[80:95]
  ds_read_b64_tr_b16 v[120:121], v19 offset:32768
  ds_read_b64_tr_b16 v[122:123], v19 offset:33280
  v_dot2_f32_bf16 v41, v129, s63, v41
  v_dot2_f32_bf16 v43, v129, v129, v43
  v_dot2_f32_bf16 v40, v130, s63, v40
  v_mfma_f32_32x32x16_bf16 v[96:111], v[140:143], v[128:131], v[96:111]
  ds_read_b64_tr_b16 v[124:125], v23 offset:32768
  ds_read_b64_tr_b16 v[126:127], v23 offset:33280
  v_dot2_f32_bf16 v42, v130, v130, v42
  v_dot2_f32_bf16 v41, v131, s63, v41
  v_dot2_f32_bf16 v43, v131, v131, v43
  s_waitcnt lgkmcnt(7)
  v_mfma_f32_32x32x16_bf16 v[64:79], v[148:151], v[144:147], v[64:79]
  v_dot2_f32_bf16 v44, v148, s63, v44
  v_dot2_f32_bf16 v46, v152, s63, v46
  v_dot2_f32_bf16 v48, v156, s63, v48
  v_dot2_f32_bf16 v45, v149, s63, v45
  v_mfma_f32_32x32x16_bf16 v[80:95], v[152:155], v[144:147], v[80:95]
  v_dot2_f32_bf16 v47, v153, s63, v47
  v_dot2_f32_bf16 v49, v157, s63, v49
  v_dot2_f32_bf16 v44, v150, s63, v44
  v_dot2_f32_bf16 v46, v154, s63, v46
  v_mfma_f32_32x32x16_bf16 v[96:111], v[156:159], v[144:147], v[96:111]
  v_dot2_f32_bf16 v48, v158, s63, v48
  v_dot2_f32_bf16 v45, v151, s63, v45
  v_dot2_f32_bf16 v47, v155, s63, v47
  v_dot2_f32_bf16 v49, v159, s63, v49
  s_waitcnt lgkmcnt(0)
  v_mfma_f32_32x32x16_bf16 v[64:79], v[116:119], v[112:115], v[64:79]
  v_mfma_f32_32x32x16_bf16 v[80:95], v[120:123], v[112:115], v[80:95]
  v_mfma_f32_32x32x16_bf16 v[96:111], v[124:127], v[112:115], v[96:111]
  v_and_b32 v2, 31, v1
  v_lshrrev_b32 v3, 5, v1
  s_mul_i32 s19, s54, 384
  s_add_u32 s19, s19, 131072
  v_lshl_add_u32 v61, v3, 4, s19
  ds_read_b128 v[160:163], v61 offset:22528
  ds_read_b128 v[164:167], v61 offset:22560
  ds_read_b128 v[168:171], v61 offset:22592
  ds_read_b128 v[172:175], v61 offset:22624
  ds_read_b128 v[176:179], v61 offset:22656
  ds_read_b128 v[180:183], v61 offset:22688
  ds_read_b128 v[184:187], v61 offset:22720
  ds_read_b128 v[188:191], v61 offset:22752
  ds_read_b128 v[192:195], v61 offset:22784
  ds_read_b128 v[196:199], v61 offset:22816
  ds_read_b128 v[200:203], v61 offset:22848
  ds_read_b128 v[204:207], v61 offset:22880
  v_add_f32 v40, v40, v41
  v_add_f32 v42, v42, v43
  v_add_f32 v44, v44, v45
  v_add_f32 v46, v46, v47
  v_add_f32 v48, v48, v49
  v_mov_b32 v41, v40
  v_mov_b32 v43, v42
  v_mov_b32 v45, v44
  v_mov_b32 v47, v46
  v_mov_b32 v49, v48
  s_nop 1
  v_permlane32_swap_b32 v40, v41
  v_permlane32_swap_b32 v42, v43
  v_permlane32_swap_b32 v44, v45
  v_permlane32_swap_b32 v46, v47
  v_permlane32_swap_b32 v48, v49
  s_nop 1
  v_add_f32 v40, v40, v41
  v_add_f32 v42, v42, v43
  v_add_f32 v44, v44, v45
  v_add_f32 v46, v46, v47
  v_add_f32 v48, v48, v49
  s_lshl_b32 s16, s53, 8
  s_add_u32 s16, s16, 133376
  v_lshl_add_u32 v60, v2, 3, s16
  s_lshl_b32 s17, s54, 9
  v_add_u32 v62, s17, v60
  s_mul_i32 s17, s53, 768
  s_add_u32 s17, s17, s19
  v_lshl_add_u32 v63, v2, 2, s17
  s_mov_b32 exec_hi, 0
  ds_write2_b32 v62, v40, v42 offset0:0 offset1:1
  ds_write2_b32 v63, v44, v46 offset0:0 offset1:32
  ds_write_b32 v63, v48 offset:256
  s_mov_b64 exec, -1
  s_waitcnt lgkmcnt(0)
  s_barrier
  ds_read_b64 v[48:49], v60
  ds_read_b64 v[46:47], v60 offset:512
  ds_read_b128 v[112:115], v61 offset:0
  ds_read_b128 v[116:119], v61 offset:32
  ds_read_b128 v[120:123], v61 offset:64
  ds_read_b128 v[124:127], v61 offset:96
  ds_read_b128 v[128:131], v61 offset:128
  ds_read_b128 v[132:135], v61 offset:160
  ds_read_b128 v[136:139], v61 offset:192
  ds_read_b128 v[140:143], v61 offset:224
  ds_read_b128 v[144:147], v61 offset:256
  ds_read_b128 v[148:151], v61 offset:288
  ds_read_b128 v[152:155], v61 offset:320
  ds_read_b128 v[156:159], v61 offset:352
  s_waitcnt lgkmcnt(12)
  v_pk_add_f32 v[48:49], v[48:49], v[46:47]
  v_mul_f32 v48, 0x3acccccd, v48
  v_mul_f32 v49, 0x3acccccd, v49
  v_fma_f32 v49, -v48, v48, v49
  v_max_f32 v49, 0, v49
  v_cvt_pk_bf16_f32 v50, v48, v49
  v_and_b32 v51, 0xffff0000, v50
  v_lshlrev_b32 v50, 16, v50
  v_add_f32 v51, 0x3727c5ac, v51
  v_cvt_pk_bf16_f32 v51, v51, v51
  v_lshlrev_b32 v51, 16, v51
  v_sqrt_f32 v51, v51
  s_nop 0
  v_cvt_pk_bf16_f32 v51, v51, v51
  v_lshlrev_b32 v51, 16, v51
  v_rcp_f32 v51, v51
  s_waitcnt lgkmcnt(3)
  ds_read_b128 v[208:211], v61 offset:768
  ds_read_b128 v[212:215], v61 offset:800
  ds_read_b128 v[216:219], v61 offset:832
  ds_read_b128 v[220:223], v61 offset:864
  ds_read_b128 v[224:227], v61 offset:896
  ds_read_b128 v[228:231], v61 offset:928
  ds_read_b128 v[232:235], v61 offset:960
  ds_read_b128 v[236:239], v61 offset:992
  ds_read_b128 v[240:243], v61 offset:1024
  ds_read_b128 v[244:247], v61 offset:1056
  ds_read_b128 v[248:251], v61 offset:1088
  ds_read_b128 v[252:255], v61 offset:1120
  s_or_b32 s16, s56, s54
  s_cmp_lg_u32 s16, 0
  s_cbranch_scc1 K1_NOST
  s_lshl_b32 s16, s53, 5
  s_add_u32 s16, s16, s58
  s_lshl_b32 s16, s16, 3
  s_add_u32 s16, s16, 14680064
  v_lshlrev_b32 v46, 3, v2
  s_mov_b32 exec_hi, 0
  buffer_store_dwordx2 v[50:51], v46, s[48:51], s16 offen
  s_mov_b64 exec, -1
K1_NOST:
  s_mul_i32 s16, s55, 48
  s_mul_i32 s17, s56, 6
  s_add_u32 s16, s16, s17
  s_mul_i32 s17, s54, 3
  s_add_u32 s16, s16, s17
  s_lshl_b32 s16, s16, 2
  s_lshl_b32 s17, s53, 1
  s_add_u32 s16, s16, s17
  s_lshl_b32 s16, s16, 10
  v_bfe_u32 v46, v1, 4, 1
  v_lshlrev_b32 v46, 10, v46
  v_and_b32 v47, 15, v1
  v_lshl_add_u32 v47, v3, 4, v47
  v_lshl_add_u32 v46, v47, 4, v46
  s_add_u32 s17, s16, 4096
  s_add_u32 s18, s16, 8192
  s_mov_b32 s4, 0xc0135761
  s_mov_b32 s6, 0xbdd2d3e8
  v_mov_b32 v52, s4
  v_mov_b32 v53, s4
  s_mov_b32 s7, s6
  s_waitcnt lgkmcnt(8)
  v_pk_add_f32 v[112:113], v[112:113], v[208:209]
  v_pk_add_f32 v[114:115], v[114:115], v[210:211]
  v_pk_add_f32 v[116:117], v[116:117], v[212:213]
  v_pk_add_f32 v[118:119], v[118:119], v[214:215]
  v_pk_add_f32 v[120:121], v[120:121], v[216:217]
  v_pk_add_f32 v[122:123], v[122:123], v[218:219]
  v_pk_add_f32 v[124:125], v[124:125], v[220:221]
  v_pk_add_f32 v[126:127], v[126:127], v[222:223]
  s_waitcnt lgkmcnt(4)
  v_pk_add_f32 v[128:129], v[128:129], v[224:225]
  v_pk_add_f32 v[130:131], v[130:131], v[226:227]
  v_pk_add_f32 v[132:133], v[132:133], v[228:229]
  v_pk_add_f32 v[134:135], v[134:135], v[230:231]
  v_pk_add_f32 v[136:137], v[136:137], v[232:233]
  v_pk_add_f32 v[138:139], v[138:139], v[234:235]
  v_pk_add_f32 v[140:141], v[140:141], v[236:237]
  v_pk_add_f32 v[142:143], v[142:143], v[238:239]
  s_waitcnt lgkmcnt(0)
  v_pk_add_f32 v[144:145], v[144:145], v[240:241]
  v_pk_add_f32 v[146:147], v[146:147], v[242:243]
  v_pk_add_f32 v[148:149], v[148:149], v[244:245]
  v_pk_add_f32 v[150:151], v[150:151], v[246:247]
  v_pk_add_f32 v[152:153], v[152:153], v[248:249]
  v_pk_add_f32 v[154:155], v[154:155], v[250:251]
  v_pk_add_f32 v[156:157], v[156:157], v[252:253]
  v_pk_add_f32 v[158:159], v[158:159], v[254:255]
  v_pk_fma_f32 v[64:65], v[112:113], v[50:51], v[64:65] op_sel:[0,0,0] op_sel_hi:[1,0,1] neg_lo:[1,0,0] neg_hi:[1,0,0]
  v_pk_fma_f32 v[66:67], v[114:115], v[50:51], v[66:67] op_sel:[0,0,0] op_sel_hi:[1,0,1] neg_lo:[1,0,0] neg_hi:[1,0,0]
  v_pk_fma_f32 v[64:65], v[64:65], v[50:51], v[160:161] op_sel:[0,1,0] op_sel_hi:[1,1,1]
  v_pk_fma_f32 v[66:67], v[66:67], v[50:51], v[162:163] op_sel:[0,1,0] op_sel_hi:[1,1,1]
  v_pk_mul_f32 v[208:209], v[64:65], v[64:65]
  v_pk_mul_f32 v[216:217], v[66:67], v[66:67]
  v_pk_fma_f32 v[208:209], v[208:209], s[6:7], v[52:53]
  v_pk_fma_f32 v[216:217], v[216:217], s[6:7], v[52:53]
  v_pk_mul_f32 v[208:209], v[208:209], v[64:65]
  v_pk_mul_f32 v[216:217], v[216:217], v[66:67]
  v_exp_f32 v208, v208
  v_exp_f32 v216, v216
  v_exp_f32 v209, v209
  v_exp_f32 v217, v217
  v_pk_add_f32 v[208:209], v[208:209], 1.0 op_sel_hi:[1,0]
  v_pk_add_f32 v[216:217], v[216:217], 1.0 op_sel_hi:[1,0]
  v_rcp_f32 v208, v208
  v_rcp_f32 v216, v216
  v_rcp_f32 v209, v209
  v_rcp_f32 v217, v217
  v_pk_mul_f32 v[208:209], v[208:209], v[64:65]
  v_pk_mul_f32 v[216:217], v[216:217], v[66:67]
  v_cvt_pk_bf16_f32 v224, v208, v209
  v_cvt_pk_bf16_f32 v225, v216, v217
  v_pk_fma_f32 v[68:69], v[116:117], v[50:51], v[68:69] op_sel:[0,0,0] op_sel_hi:[1,0,1] neg_lo:[1,0,0] neg_hi:[1,0,0]
  v_pk_fma_f32 v[70:71], v[118:119], v[50:51], v[70:71] op_sel:[0,0,0] op_sel_hi:[1,0,1] neg_lo:[1,0,0] neg_hi:[1,0,0]
  v_pk_fma_f32 v[68:69], v[68:69], v[50:51], v[164:165] op_sel:[0,1,0] op_sel_hi:[1,1,1]
  v_pk_fma_f32 v[70:71], v[70:71], v[50:51], v[166:167] op_sel:[0,1,0] op_sel_hi:[1,1,1]
  v_pk_mul_f32 v[208:209], v[68:69], v[68:69]
  v_pk_mul_f32 v[216:217], v[70:71], v[70:71]
  v_pk_fma_f32 v[208:209], v[208:209], s[6:7], v[52:53]
  v_pk_fma_f32 v[216:217], v[216:217], s[6:7], v[52:53]
  v_pk_mul_f32 v[208:209], v[208:209], v[68:69]
  v_pk_mul_f32 v[216:217], v[216:217], v[70:71]
  v_exp_f32 v208, v208
  v_exp_f32 v216, v216
  v_exp_f32 v209, v209
  v_exp_f32 v217, v217
  v_pk_add_f32 v[208:209], v[208:209], 1.0 op_sel_hi:[1,0]
  v_pk_add_f32 v[216:217], v[216:217], 1.0 op_sel_hi:[1,0]
  v_rcp_f32 v208, v208
  v_rcp_f32 v216, v216
  v_rcp_f32 v209, v209
  v_rcp_f32 v217, v217
  v_pk_mul_f32 v[208:209], v[208:209], v[68:69]
  v_pk_mul_f32 v[216:217], v[216:217], v[70:71]
  v_cvt_pk_bf16_f32 v226, v208, v209
  v_cvt_pk_bf16_f32 v227, v216, v217
  buffer_store_dwordx4 v[224:227], v46, s[48:51], s16 offen offset:0 sc1
  v_pk_fma_f32 v[72:73], v[120:121], v[50:51], v[72:73] op_sel:[0,0,0] op_sel_hi:[1,0,1] neg_lo:[1,0,0] neg_hi:[1,0,0]
  v_pk_fma_f32 v[74:75], v[122:123], v[50:51], v[74:75] op_sel:[0,0,0] op_sel_hi:[1,0,1] neg_lo:[1,0,0] neg_hi:[1,0,0]
  v_pk_fma_f32 v[72:73], v[72:73], v[50:51], v[168:169] op_sel:[0,1,0] op_sel_hi:[1,1,1]
  v_pk_fma_f32 v[74:75], v[74:75], v[50:51], v[170:171] op_sel:[0,1,0] op_sel_hi:[1,1,1]
  v_pk_mul_f32 v[208:209], v[72:73], v[72:73]
  v_pk_mul_f32 v[216:217], v[74:75], v[74:75]
  v_pk_fma_f32 v[208:209], v[208:209], s[6:7], v[52:53]
  v_pk_fma_f32 v[216:217], v[216:217], s[6:7], v[52:53]
  v_pk_mul_f32 v[208:209], v[208:209], v[72:73]
  v_pk_mul_f32 v[216:217], v[216:217], v[74:75]
  v_exp_f32 v208, v208
  v_exp_f32 v216, v216
  v_exp_f32 v209, v209
  v_exp_f32 v217, v217
  v_pk_add_f32 v[208:209], v[208:209], 1.0 op_sel_hi:[1,0]
  v_pk_add_f32 v[216:217], v[216:217], 1.0 op_sel_hi:[1,0]
  v_rcp_f32 v208, v208
  v_rcp_f32 v216, v216
  v_rcp_f32 v209, v209
  v_rcp_f32 v217, v217
  v_pk_mul_f32 v[208:209], v[208:209], v[72:73]
  v_pk_mul_f32 v[216:217], v[216:217], v[74:75]
  v_cvt_pk_bf16_f32 v232, v208, v209
  v_cvt_pk_bf16_f32 v233, v216, v217
  v_pk_fma_f32 v[76:77], v[124:125], v[50:51], v[76:77] op_sel:[0,0,0] op_sel_hi:[1,0,1] neg_lo:[1,0,0] neg_hi:[1,0,0]
  v_pk_fma_f32 v[78:79], v[126:127], v[50:51], v[78:79] op_sel:[0,0,0] op_sel_hi:[1,0,1] neg_lo:[1,0,0] neg_hi:[1,0,0]
  v_pk_fma_f32 v[76:77], v[76:77], v[50:51], v[172:173] op_sel:[0,1,0] op_sel_hi:[1,1,1]
  v_pk_fma_f32 v[78:79], v[78:79], v[50:51], v[174:175] op_sel:[0,1,0] op_sel_hi:[1,1,1]
  v_pk_mul_f32 v[208:209], v[76:77], v[76:77]
  v_pk_mul_f32 v[216:217], v[78:79], v[78:79]
  v_pk_fma_f32 v[208:209], v[208:209], s[6:7], v[52:53]
  v_pk_fma_f32 v[216:217], v[216:217], s[6:7], v[52:53]
  v_pk_mul_f32 v[208:209], v[208:209], v[76:77]
  v_pk_mul_f32 v[216:217], v[216:217], v[78:79]
  v_exp_f32 v208, v208
  v_exp_f32 v216, v216
  v_exp_f32 v209, v209
  v_exp_f32 v217, v217
  v_pk_add_f32 v[208:209], v[208:209], 1.0 op_sel_hi:[1,0]
  v_pk_add_f32 v[216:217], v[216:217], 1.0 op_sel_hi:[1,0]
  v_rcp_f32 v208, v208
  v_rcp_f32 v216, v216
  v_rcp_f32 v209, v209
  v_rcp_f32 v217, v217
  v_pk_mul_f32 v[208:209], v[208:209], v[76:77]
  v_pk_mul_f32 v[216:217], v[216:217], v[78:79]
  v_cvt_pk_bf16_f32 v234, v208, v209
  v_cvt_pk_bf16_f32 v235, v216, v217
  buffer_store_dwordx4 v[232:235], v46, s[48:51], s16 offen offset:512 sc1
  v_pk_fma_f32 v[80:81], v[128:129], v[50:51], v[80:81] op_sel:[0,0,0] op_sel_hi:[1,0,1] neg_lo:[1,0,0] neg_hi:[1,0,0]
  v_pk_fma_f32 v[82:83], v[130:131], v[50:51], v[82:83] op_sel:[0,0,0] op_sel_hi:[1,0,1] neg_lo:[1,0,0] neg_hi:[1,0,0]
  v_pk_fma_f32 v[80:81], v[80:81], v[50:51], v[176:177] op_sel:[0,1,0] op_sel_hi:[1,1,1]
  v_pk_fma_f32 v[82:83], v[82:83], v[50:51], v[178:179] op_sel:[0,1,0] op_sel_hi:[1,1,1]
  v_pk_mul_f32 v[208:209], v[80:81], v[80:81]
  v_pk_mul_f32 v[216:217], v[82:83], v[82:83]
  v_pk_fma_f32 v[208:209], v[208:209], s[6:7], v[52:53]
  v_pk_fma_f32 v[216:217], v[216:217], s[6:7], v[52:53]
  v_pk_mul_f32 v[208:209], v[208:209], v[80:81]
  v_pk_mul_f32 v[216:217], v[216:217], v[82:83]
  v_exp_f32 v208, v208
  v_exp_f32 v216, v216
  v_exp_f32 v209, v209
  v_exp_f32 v217, v217
  v_pk_add_f32 v[208:209], v[208:209], 1.0 op_sel_hi:[1,0]
  v_pk_add_f32 v[216:217], v[216:217], 1.0 op_sel_hi:[1,0]
  v_rcp_f32 v208, v208
  v_rcp_f32 v216, v216
  v_rcp_f32 v209, v209
  v_rcp_f32 v217, v217
  v_pk_mul_f32 v[208:209], v[208:209], v[80:81]
  v_pk_mul_f32 v[216:217], v[216:217], v[82:83]
  v_cvt_pk_bf16_f32 v224, v208, v209
  v_cvt_pk_bf16_f32 v225, v216, v217
  v_pk_fma_f32 v[84:85], v[132:133], v[50:51], v[84:85] op_sel:[0,0,0] op_sel_hi:[1,0,1] neg_lo:[1,0,0] neg_hi:[1,0,0]
  v_pk_fma_f32 v[86:87], v[134:135], v[50:51], v[86:87] op_sel:[0,0,0] op_sel_hi:[1,0,1] neg_lo:[1,0,0] neg_hi:[1,0,0]
  v_pk_fma_f32 v[84:85], v[84:85], v[50:51], v[180:181] op_sel:[0,1,0] op_sel_hi:[1,1,1]
  v_pk_fma_f32 v[86:87], v[86:87], v[50:51], v[182:183] op_sel:[0,1,0] op_sel_hi:[1,1,1]
  v_pk_mul_f32 v[208:209], v[84:85], v[84:85]
  v_pk_mul_f32 v[216:217], v[86:87], v[86:87]
  v_pk_fma_f32 v[208:209], v[208:209], s[6:7], v[52:53]
  v_pk_fma_f32 v[216:217], v[216:217], s[6:7], v[52:53]
  v_pk_mul_f32 v[208:209], v[208:209], v[84:85]
  v_pk_mul_f32 v[216:217], v[216:217], v[86:87]
  v_exp_f32 v208, v208
  v_exp_f32 v216, v216
  v_exp_f32 v209, v209
  v_exp_f32 v217, v217
  v_pk_add_f32 v[208:209], v[208:209], 1.0 op_sel_hi:[1,0]
  v_pk_add_f32 v[216:217], v[216:217], 1.0 op_sel_hi:[1,0]
  v_rcp_f32 v208, v208
  v_rcp_f32 v216, v216
  v_rcp_f32 v209, v209
  v_rcp_f32 v217, v217
  v_pk_mul_f32 v[208:209], v[208:209], v[84:85]
  v_pk_mul_f32 v[216:217], v[216:217], v[86:87]
  v_cvt_pk_bf16_f32 v226, v208, v209
  v_cvt_pk_bf16_f32 v227, v216, v217
  buffer_store_dwordx4 v[224:227], v46, s[48:51], s17 offen offset:0 sc1
  v_pk_fma_f32 v[88:89], v[136:137], v[50:51], v[88:89] op_sel:[0,0,0] op_sel_hi:[1,0,1] neg_lo:[1,0,0] neg_hi:[1,0,0]
  v_pk_fma_f32 v[90:91], v[138:139], v[50:51], v[90:91] op_sel:[0,0,0] op_sel_hi:[1,0,1] neg_lo:[1,0,0] neg_hi:[1,0,0]
  v_pk_fma_f32 v[88:89], v[88:89], v[50:51], v[184:185] op_sel:[0,1,0] op_sel_hi:[1,1,1]
  v_pk_fma_f32 v[90:91], v[90:91], v[50:51], v[186:187] op_sel:[0,1,0] op_sel_hi:[1,1,1]
  v_pk_mul_f32 v[208:209], v[88:89], v[88:89]
  v_pk_mul_f32 v[216:217], v[90:91], v[90:91]
  v_pk_fma_f32 v[208:209], v[208:209], s[6:7], v[52:53]
  v_pk_fma_f32 v[216:217], v[216:217], s[6:7], v[52:53]
  v_pk_mul_f32 v[208:209], v[208:209], v[88:89]
  v_pk_mul_f32 v[216:217], v[216:217], v[90:91]
  v_exp_f32 v208, v208
  v_exp_f32 v216, v216
  v_exp_f32 v209, v209
  v_exp_f32 v217, v217
  v_pk_add_f32 v[208:209], v[208:209], 1.0 op_sel_hi:[1,0]
  v_pk_add_f32 v[216:217], v[216:217], 1.0 op_sel_hi:[1,0]
  v_rcp_f32 v208, v208
  v_rcp_f32 v216, v216
  v_rcp_f32 v209, v209
  v_rcp_f32 v217, v217
  v_pk_mul_f32 v[208:209], v[208:209], v[88:89]
  v_pk_mul_f32 v[216:217], v[216:217], v[90:91]
  v_cvt_pk_bf16_f32 v232, v208, v209
  v_cvt_pk_bf16_f32 v233, v216, v217
  v_pk_fma_f32 v[92:93], v[140:141], v[50:51], v[92:93] op_sel:[0,0,0] op_sel_hi:[1,0,1] neg_lo:[1,0,0] neg_hi:[1,0,0]
  v_pk_fma_f32 v[94:95], v[142:143], v[50:51], v[94:95] op_sel:[0,0,0] op_sel_hi:[1,0,1] neg_lo:[1,0,0] neg_hi:[1,0,0]
  v_pk_fma_f32 v[92:93], v[92:93], v[50:51], v[188:189] op_sel:[0,1,0] op_sel_hi:[1,1,1]
  v_pk_fma_f32 v[94:95], v[94:95], v[50:51], v[190:191] op_sel:[0,1,0] op_sel_hi:[1,1,1]
  v_pk_mul_f32 v[208:209], v[92:93], v[92:93]
  v_pk_mul_f32 v[216:217], v[94:95], v[94:95]
  v_pk_fma_f32 v[208:209], v[208:209], s[6:7], v[52:53]
  v_pk_fma_f32 v[216:217], v[216:217], s[6:7], v[52:53]
  v_pk_mul_f32 v[208:209], v[208:209], v[92:93]
  v_pk_mul_f32 v[216:217], v[216:217], v[94:95]
  v_exp_f32 v208, v208
  v_exp_f32 v216, v216
  v_exp_f32 v209, v209
  v_exp_f32 v217, v217
  v_pk_add_f32 v[208:209], v[208:209], 1.0 op_sel_hi:[1,0]
  v_pk_add_f32 v[216:217], v[216:217], 1.0 op_sel_hi:[1,0]
  v_rcp_f32 v208, v208
  v_rcp_f32 v216, v216
  v_rcp_f32 v209, v209
  v_rcp_f32 v217, v217
  v_pk_mul_f32 v[208:209], v[208:209], v[92:93]
  v_pk_mul_f32 v[216:217], v[216:217], v[94:95]
  v_cvt_pk_bf16_f32 v234, v208, v209
  v_cvt_pk_bf16_f32 v235, v216, v217
  buffer_store_dwordx4 v[232:235], v46, s[48:51], s17 offen offset:512 sc1
  v_pk_fma_f32 v[96:97], v[144:145], v[50:51], v[96:97] op_sel:[0,0,0] op_sel_hi:[1,0,1] neg_lo:[1,0,0] neg_hi:[1,0,0]
  v_pk_fma_f32 v[98:99], v[146:147], v[50:51], v[98:99] op_sel:[0,0,0] op_sel_hi:[1,0,1] neg_lo:[1,0,0] neg_hi:[1,0,0]
  v_pk_fma_f32 v[96:97], v[96:97], v[50:51], v[192:193] op_sel:[0,1,0] op_sel_hi:[1,1,1]
  v_pk_fma_f32 v[98:99], v[98:99], v[50:51], v[194:195] op_sel:[0,1,0] op_sel_hi:[1,1,1]
  v_pk_mul_f32 v[208:209], v[96:97], v[96:97]
  v_pk_mul_f32 v[216:217], v[98:99], v[98:99]
  v_pk_fma_f32 v[208:209], v[208:209], s[6:7], v[52:53]
  v_pk_fma_f32 v[216:217], v[216:217], s[6:7], v[52:53]
  v_pk_mul_f32 v[208:209], v[208:209], v[96:97]
  v_pk_mul_f32 v[216:217], v[216:217], v[98:99]
  v_exp_f32 v208, v208
  v_exp_f32 v216, v216
  v_exp_f32 v209, v209
  v_exp_f32 v217, v217
  v_pk_add_f32 v[208:209], v[208:209], 1.0 op_sel_hi:[1,0]
  v_pk_add_f32 v[216:217], v[216:217], 1.0 op_sel_hi:[1,0]
  v_rcp_f32 v208, v208
  v_rcp_f32 v216, v216
  v_rcp_f32 v209, v209
  v_rcp_f32 v217, v217
  v_pk_mul_f32 v[208:209], v[208:209], v[96:97]
  v_pk_mul_f32 v[216:217], v[216:217], v[98:99]
  v_cvt_pk_bf16_f32 v224, v208, v209
  v_cvt_pk_bf16_f32 v225, v216, v217
  v_pk_fma_f32 v[100:101], v[148:149], v[50:51], v[100:101] op_sel:[0,0,0] op_sel_hi:[1,0,1] neg_lo:[1,0,0] neg_hi:[1,0,0]
  v_pk_fma_f32 v[102:103], v[150:151], v[50:51], v[102:103] op_sel:[0,0,0] op_sel_hi:[1,0,1] neg_lo:[1,0,0] neg_hi:[1,0,0]
  v_pk_fma_f32 v[100:101], v[100:101], v[50:51], v[196:197] op_sel:[0,1,0] op_sel_hi:[1,1,1]
  v_pk_fma_f32 v[102:103], v[102:103], v[50:51], v[198:199] op_sel:[0,1,0] op_sel_hi:[1,1,1]
  v_pk_mul_f32 v[208:209], v[100:101], v[100:101]
  v_pk_mul_f32 v[216:217], v[102:103], v[102:103]
  v_pk_fma_f32 v[208:209], v[208:209], s[6:7], v[52:53]
  v_pk_fma_f32 v[216:217], v[216:217], s[6:7], v[52:53]
  v_pk_mul_f32 v[208:209], v[208:209], v[100:101]
  v_pk_mul_f32 v[216:217], v[216:217], v[102:103]
  v_exp_f32 v208, v208
  v_exp_f32 v216, v216
  v_exp_f32 v209, v209
  v_exp_f32 v217, v217
  v_pk_add_f32 v[208:209], v[208:209], 1.0 op_sel_hi:[1,0]
  v_pk_add_f32 v[216:217], v[216:217], 1.0 op_sel_hi:[1,0]
  v_rcp_f32 v208, v208
  v_rcp_f32 v216, v216
  v_rcp_f32 v209, v209
  v_rcp_f32 v217, v217
  v_pk_mul_f32 v[208:209], v[208:209], v[100:101]
  v_pk_mul_f32 v[216:217], v[216:217], v[102:103]
  v_cvt_pk_bf16_f32 v226, v208, v209
  v_cvt_pk_bf16_f32 v227, v216, v217
  buffer_store_dwordx4 v[224:227], v46, s[48:51], s18 offen offset:0 sc1
  v_pk_fma_f32 v[104:105], v[152:153], v[50:51], v[104:105] op_sel:[0,0,0] op_sel_hi:[1,0,1] neg_lo:[1,0,0] neg_hi:[1,0,0]
  v_pk_fma_f32 v[106:107], v[154:155], v[50:51], v[106:107] op_sel:[0,0,0] op_sel_hi:[1,0,1] neg_lo:[1,0,0] neg_hi:[1,0,0]
  v_pk_fma_f32 v[104:105], v[104:105], v[50:51], v[200:201] op_sel:[0,1,0] op_sel_hi:[1,1,1]
  v_pk_fma_f32 v[106:107], v[106:107], v[50:51], v[202:203] op_sel:[0,1,0] op_sel_hi:[1,1,1]
  v_pk_mul_f32 v[208:209], v[104:105], v[104:105]
  v_pk_mul_f32 v[216:217], v[106:107], v[106:107]
  v_pk_fma_f32 v[208:209], v[208:209], s[6:7], v[52:53]
  v_pk_fma_f32 v[216:217], v[216:217], s[6:7], v[52:53]
  v_pk_mul_f32 v[208:209], v[208:209], v[104:105]
  v_pk_mul_f32 v[216:217], v[216:217], v[106:107]
  v_exp_f32 v208, v208
  v_exp_f32 v216, v216
  v_exp_f32 v209, v209
  v_exp_f32 v217, v217
  v_pk_add_f32 v[208:209], v[208:209], 1.0 op_sel_hi:[1,0]
  v_pk_add_f32 v[216:217], v[216:217], 1.0 op_sel_hi:[1,0]
  v_rcp_f32 v208, v208
  v_rcp_f32 v216, v216
  v_rcp_f32 v209, v209
  v_rcp_f32 v217, v217
  v_pk_mul_f32 v[208:209], v[208:209], v[104:105]
  v_pk_mul_f32 v[216:217], v[216:217], v[106:107]
  v_cvt_pk_bf16_f32 v232, v208, v209
  v_cvt_pk_bf16_f32 v233, v216, v217
  v_pk_fma_f32 v[108:109], v[156:157], v[50:51], v[108:109] op_sel:[0,0,0] op_sel_hi:[1,0,1] neg_lo:[1,0,0] neg_hi:[1,0,0]
  v_pk_fma_f32 v[110:111], v[158:159], v[50:51], v[110:111] op_sel:[0,0,0] op_sel_hi:[1,0,1] neg_lo:[1,0,0] neg_hi:[1,0,0]
  v_pk_fma_f32 v[108:109], v[108:109], v[50:51], v[204:205] op_sel:[0,1,0] op_sel_hi:[1,1,1]
  v_pk_fma_f32 v[110:111], v[110:111], v[50:51], v[206:207] op_sel:[0,1,0] op_sel_hi:[1,1,1]
  v_pk_mul_f32 v[208:209], v[108:109], v[108:109]
  v_pk_mul_f32 v[216:217], v[110:111], v[110:111]
  v_pk_fma_f32 v[208:209], v[208:209], s[6:7], v[52:53]
  v_pk_fma_f32 v[216:217], v[216:217], s[6:7], v[52:53]
  v_pk_mul_f32 v[208:209], v[208:209], v[108:109]
  v_pk_mul_f32 v[216:217], v[216:217], v[110:111]
  v_exp_f32 v208, v208
  v_exp_f32 v216, v216
  v_exp_f32 v209, v209
  v_exp_f32 v217, v217
  v_pk_add_f32 v[208:209], v[208:209], 1.0 op_sel_hi:[1,0]
  v_pk_add_f32 v[216:217], v[216:217], 1.0 op_sel_hi:[1,0]
  v_rcp_f32 v208, v208
  v_rcp_f32 v216, v216
  v_rcp_f32 v209, v209
  v_rcp_f32 v217, v217
  v_pk_mul_f32 v[208:209], v[208:209], v[108:109]
  v_pk_mul_f32 v[216:217], v[216:217], v[110:111]
  v_cvt_pk_bf16_f32 v234, v208, v209
  v_cvt_pk_bf16_f32 v235, v216, v217
  buffer_store_dwordx4 v[232:235], v46, s[48:51], s18 offen offset:512 sc1
  s_endpgm
K1_HELP:
  s_sub_u32 s52, s52, 4
  s_lshl_b32 s57, s52, 11
  v_add_u32 v0, 0xffffff00, v0
  s_and_b32 s17, s3, 3
  s_lshl_b32 s17, s17, 9
  s_lshl_b32 s18, s4, 4
  s_add_u32 s17, s17, s18
  s_lshl_b32 s18, s52, 2
  s_add_u32 s17, s17, s18
  v_add_u32 v32, s17, v1
  v_mul_u32_u24 v32, 1280, v32
  s_lshr_b32 s16, s52, 1
  s_lshl_b32 s18, s4, 1
  s_add_u32 s16, s16, s18
  s_mul_i32 s16, s16, 3072
  s_lshr_b32 s18, s3, 2
  s_mul_i32 s18, s18, 1536
  s_add_u32 s16, s16, s18
  s_and_b32 s18, s52, 1
  s_mul_i32 s18, s18, 768
  s_add_u32 s16, s16, s18
  v_lshl_add_u32 v33, v1, 7, s16
  s_mul_i32 s18, s56, 384
  v_lshl_add_u32 v34, v0, 1, s18
  s_lshl_b32 s5, s2, 2
  s_add_u32 s5, s5, s52
  s_min_u32 s5, s5, 959
  s_mul_i32 s6, s5, 3277
  s_lshr_b32 s6, s6, 16
  s_mul_i32 s7, s6, 20
  s_sub_u32 s7, s5, s7
  v_lshrrev_b32 v60, 2, v1
  v_and_b32 v61, 3, v1
  v_mul_u32_u24 v60, 1280, v60
  v_lshl_add_u32 v50, v61, 4, v60
  s_mul_i32 s8, s6, 40960
  s_lshl_b32 s9, s7, 6
  s_add_u32 s8, s8, s9
  s_add_u32 s9, s8, 20480
  s_lshr_b32 s10, s2, 3
  s_lshl_b32 s10, s10, 6
  s_lshl_b32 s11, s52, 4
  s_add_u32 s10, s10, s11
  s_and_b32 s11, s2, 7
  s_mul_i32 s11, s11, 80
  s_mul_i32 s12, s10, 1280
  s_lshl_b32 s13, s11, 1
  s_add_u32 s12, s12, s13
  s_sub_u32 s13, s12, 3840
  s_lshl_b32 s14, s11, 3
  v_lshl_add_u32 v57, v1, 4, s14
  s_mul_i32 s15, s52, 5632
  v_add_u32 v60, 0, v1
  v_mul_u32_u24 v61, 6554, v60
  v_lshrrev_b32 v61, 16, v61
  v_mul_u32_u24 v63, 10, v61
  v_sub_u32 v63, v60, v63
  v_mul_u32_u24 v61, 1280, v61
  v_lshl_add_u32 v61, v63, 4, v61
  v_add_u32 v51, s13, v61
  v_add_u32 v54, s12, v61
  v_add_u32 v60, 64, v1
  v_mul_u32_u24 v61, 6554, v60
  v_lshrrev_b32 v61, 16, v61
  v_mul_u32_u24 v63, 10, v61
  v_sub_u32 v63, v60, v63
  v_mul_u32_u24 v61, 1280, v61
  v_lshl_add_u32 v61, v63, 4, v61
  v_add_u32 v52, s13, v61
  v_add_u32 v55, s12, v61
  v_add_u32 v60, 128, v1
  v_mul_u32_u24 v61, 6554, v60
  v_lshrrev_b32 v61, 16, v61
  v_mul_u32_u24 v63, 10, v61
  v_sub_u32 v63, v60, v63
  v_mul_u32_u24 v61, 1280, v61
  v_lshl_add_u32 v61, v63, 4, v61
  v_add_u32 v53, s13, v61
  v_add_u32 v56, s12, v61
  v_lshrrev_b32 v8, 5, v1
  v_bfe_u32 v9, v1, 4, 1
  v_lshlrev_b32 v8, 4, v8
  v_lshl_add_u32 v8, v9, 2, v8
  v_bfe_u32 v9, v1, 2, 2
  v_add_u32 v8, v8, v9
  v_and_b32 v9, 3, v1
  v_lshlrev_b32 v9, 3, v9
  v_lshl_add_u32 v8, v8, 6, v9
  s_add_u32 s16, s57, 153600
  v_add_u32 v8, s16, v8
  s_lshl_b32 s7, s7, 1
  s_mul_i32 s4, s7, 52429
  s_lshr_b32 s4, s4, 18
  s_mul_i32 s5, s4, 5
  s_sub_u32 s5, s7, s5
  s_mul_i32 s4, s4, 48
  s_add_u32 s4, s4, s6
  s_mul_i32 s4, s4, 5
  s_add_u32 s4, s4, s5
  s_lshl_b32 s4, s4, 10
  s_add_u32 s4, s4, 6291456
  s_add_u32 s7, s7, 1
  s_mul_i32 s5, s7, 52429
  s_lshr_b32 s5, s5, 18
  s_mul_i32 s16, s5, 5
  s_sub_u32 s16, s7, s16
  s_mul_i32 s5, s5, 48
  s_add_u32 s5, s5, s6
  s_mul_i32 s5, s5, 5
  s_add_u32 s5, s5, s16
  s_lshl_b32 s5, s5, 10
  s_add_u32 s5, s5, 6291456
  v_lshlrev_b32 v9, 4, v1
  s_mul_i32 s17, s2, 10240
  s_mul_i32 s18, s52, 2560
  s_add_u32 s17, s17, s18
  s_add_u32 s17, s17, 11534336
  s_lshl_b32 s18, s2, 7
  s_lshl_b32 s19, s52, 5
  s_add_u32 s18, s18, s19
  s_add_u32 s18, s18, 14712832
  v_lshlrev_b32 v35, 4, v1
  v_mov_b32 v40, 0
  v_mov_b32 v41, 0
  v_mov_b32 v42, 0
  v_mov_b32 v43, 0
  v_mov_b32 v44, -1
  v_mov_b32 v45, -1
  v_mov_b32 v46, -1
  v_mov_b32 v47, -1
  s_waitcnt lgkmcnt(0)
  v_mov_b32 v36, 161792
  v_add_u32 v36, v35, v36
  s_mov_b64 exec, 15
  ds_write_b128 v36, v[40:43]
  s_mov_b64 exec, -1
  s_waitcnt lgkmcnt(0)
  s_barrier
  s_add_u32 m0, s57, 153600
  s_nop 0
  buffer_load_dwordx4 v50, s[44:47], s8 offen lds
  s_add_u32 m0, s57, 154624
  s_nop 0
  buffer_load_dwordx4 v50, s[44:47], s9 offen lds
  s_barrier
  buffer_load_ushort v62, v34, s[40:43], 0 offen
  s_add_u32 m0, s15, 131072
  s_nop 0
  buffer_load_dwordx4 v51, s[28:31], 0 offen lds
  s_barrier
  s_add_u32 m0, s15, 132096
  s_nop 0
  buffer_load_dwordx4 v52, s[28:31], 0 offen lds
  s_add_u32 m0, s15, 133120
  s_nop 0
  buffer_load_dwordx4 v53, s[28:31], 0 offen lds
  s_barrier
  s_add_u32 m0, s15, 134144
  s_nop 0
  buffer_load_dwordx4 v54, s[32:35], 0 offen lds
  s_add_u32 m0, s15, 135168
  s_nop 0
  buffer_load_dwordx4 v55, s[32:35], 0 offen lds
  s_barrier
  s_mov_b32 exec_hi, 0
  s_add_u32 m0, s15, 136192
  s_nop 0
  buffer_load_dwordx4 v56, s[32:35], 0 offen lds
  s_mov_b32 exec_hi, 0xff
  buffer_load_dwordx4 v[244:247], v57, s[36:39], 0 offen
  s_mov_b64 exec, 3
  buffer_store_dwordx4 v[40:43], v35, s[48:51], s18 offen
  s_mov_b64 exec, -1
  s_barrier
  s_barrier
  s_waitcnt vmcnt(1)
  ds_read_b64_tr_b16 v[12:13], v8
  ds_read_b64_tr_b16 v[14:15], v8 offset:512
  ds_read_b64_tr_b16 v[16:17], v8 offset:32
  ds_read_b64_tr_b16 v[18:19], v8 offset:544
  s_waitcnt lgkmcnt(2)
  buffer_store_dwordx4 v[12:15], v9, s[48:51], s4 offen sc1
  s_waitcnt lgkmcnt(0)
  buffer_store_dwordx4 v[16:19], v9, s[48:51], s5 offen sc1
  s_barrier
  v_lshlrev_b32 v62, 16, v62
  v_lshlrev_b32 v60, 2, v0
  v_add_u32 v60, 153600, v60
  v_cmp_gt_u32 vcc, 192, v0
  s_and_saveexec_b64 s[12:13], vcc
  ds_write_b32 v60, v62
  s_mov_b64 exec, s[12:13]
  s_add_u32 s16, s15, 131072
  v_lshl_add_u32 v10, v1, 2, s16
  ds_read_b32 v112, v10 offset:0
  ds_read_b32 v113, v10 offset:160
  ds_read_b32 v114, v10 offset:320
  ds_read_b32 v115, v10 offset:480
  ds_read_b32 v116, v10 offset:640
  ds_read_b32 v117, v10 offset:800
  ds_read_b32 v118, v10 offset:960
  ds_read_b32 v119, v10 offset:1120
  ds_read_b32 v120, v10 offset:1280
  ds_read_b32 v121, v10 offset:1440
  ds_read_b32 v122, v10 offset:1600
  ds_read_b32 v123, v10 offset:1760
  s_waitcnt lgkmcnt(4)
  ds_read_b32 v124, v10 offset:1920
  ds_read_b32 v125, v10 offset:2080
  ds_read_b32 v126, v10 offset:2240
  ds_read_b32 v127, v10 offset:2400
  ds_read_b32 v128, v10 offset:2560
  ds_read_b32 v129, v10 offset:2720
  ds_read_b32 v130, v10 offset:2880
  s_waitcnt lgkmcnt(4)
  ds_read_b32 v132, v10 offset:3072
  ds_read_b32 v133, v10 offset:3232
  ds_read_b32 v134, v10 offset:3392
  ds_read_b32 v135, v10 offset:3552
  ds_read_b32 v136, v10 offset:3712
  ds_read_b32 v137, v10 offset:3872
  ds_read_b32 v138, v10 offset:4032
  ds_read_b32 v139, v10 offset:4192
  s_waitcnt lgkmcnt(4)
  ds_read_b32 v140, v10 offset:4352
  ds_read_b32 v141, v10 offset:4512
  ds_read_b32 v142, v10 offset:4672
  ds_read_b32 v143, v10 offset:4832
  ds_read_b32 v144, v10 offset:4992
  ds_read_b32 v145, v10 offset:5152
  ds_read_b32 v146, v10 offset:5312
  ds_read_b32 v147, v10 offset:5472
  s_mov_b32 s16, 0xffff0000
  s_waitcnt lgkmcnt(8)
  v_lshlrev_b32 v152, 16, v244
  v_lshlrev_b32 v153, 16, v246
  v_and_b32 v154, s16, v244
  v_and_b32 v155, s16, v246
  v_lshlrev_b32 v156, 16, v245
  v_lshlrev_b32 v157, 16, v247
  v_and_b32 v158, s16, v245
  v_and_b32 v159, s16, v247
  v_lshlrev_b32 v160, 16, v112
  v_and_b32 v161, s16, v112
  v_lshlrev_b32 v162, 16, v113
  v_and_b32 v163, s16, v113
  v_lshlrev_b32 v164, 16, v114
  v_and_b32 v165, s16, v114
  v_lshlrev_b32 v166, 16, v115
  v_and_b32 v167, s16, v115
  v_lshlrev_b32 v168, 16, v116
  v_and_b32 v169, s16, v116
  v_lshlrev_b32 v170, 16, v117
  v_and_b32 v171, s16, v117
  v_lshlrev_b32 v172, 16, v118
  v_and_b32 v173, s16, v118
  v_lshlrev_b32 v174, 16, v119
  v_and_b32 v175, s16, v119
  v_lshlrev_b32 v176, 16, v120
  v_and_b32 v177, s16, v120
  v_lshlrev_b32 v178, 16, v121
  v_and_b32 v179, s16, v121
  v_lshlrev_b32 v180, 16, v122
  v_and_b32 v181, s16, v122
  v_lshlrev_b32 v182, 16, v123
  v_and_b32 v183, s16, v123
  v_lshlrev_b32 v184, 16, v124
  v_and_b32 v185, s16, v124
  v_lshlrev_b32 v186, 16, v125
  v_and_b32 v187, s16, v125
  v_lshlrev_b32 v188, 16, v126
  v_and_b32 v189, s16, v126
  v_lshlrev_b32 v190, 16, v127
  v_and_b32 v191, s16, v127
  v_lshlrev_b32 v192, 16, v128
  v_and_b32 v193, s16, v128
  v_lshlrev_b32 v194, 16, v129
  v_and_b32 v195, s16, v129
  v_lshlrev_b32 v196, 16, v130
  v_and_b32 v197, s16, v130
  s_waitcnt lgkmcnt(0)
  v_lshlrev_b32 v198, 16, v132
  v_and_b32 v199, s16, v132
  v_pk_mul_f32 v[200:201], v[166:167], v[152:153]
  v_pk_fma_f32 v[200:201], v[164:165], v[154:155], v[200:201]
  v_pk_fma_f32 v[200:201], v[162:163], v[156:157], v[200:201]
  v_pk_fma_f32 v[200:201], v[160:161], v[158:159], v[200:201]
  v_pk_mul_f32 v[200:201], v[200:201], v[198:199]
  v_lshlrev_b32 v198, 16, v133
  v_and_b32 v199, s16, v133
  v_pk_mul_f32 v[202:203], v[168:169], v[152:153]
  v_pk_fma_f32 v[202:203], v[166:167], v[154:155], v[202:203]
  v_pk_fma_f32 v[202:203], v[164:165], v[156:157], v[202:203]
  v_pk_fma_f32 v[202:203], v[162:163], v[158:159], v[202:203]
  v_pk_mul_f32 v[202:203], v[202:203], v[198:199]
  s_waitcnt lgkmcnt(0)
  s_barrier
  v_lshlrev_b32 v198, 16, v134
  v_and_b32 v199, s16, v134
  v_pk_mul_f32 v[204:205], v[170:171], v[152:153]
  v_pk_fma_f32 v[204:205], v[168:169], v[154:155], v[204:205]
  v_pk_fma_f32 v[204:205], v[166:167], v[156:157], v[204:205]
  v_pk_fma_f32 v[204:205], v[164:165], v[158:159], v[204:205]
  v_pk_mul_f32 v[204:205], v[204:205], v[198:199]
  v_lshlrev_b32 v198, 16, v135
  v_and_b32 v199, s16, v135
  v_pk_mul_f32 v[206:207], v[172:173], v[152:153]
  v_pk_fma_f32 v[206:207], v[170:171], v[154:155], v[206:207]
  v_pk_fma_f32 v[206:207], v[168:169], v[156:157], v[206:207]
  v_pk_fma_f32 v[206:207], v[166:167], v[158:159], v[206:207]
  v_pk_mul_f32 v[206:207], v[206:207], v[198:199]
  v_lshlrev_b32 v198, 16, v136
  v_and_b32 v199, s16, v136
  v_pk_mul_f32 v[208:209], v[174:175], v[152:153]
  v_pk_fma_f32 v[208:209], v[172:173], v[154:155], v[208:209]
  v_pk_fma_f32 v[208:209], v[170:171], v[156:157], v[208:209]
  v_pk_fma_f32 v[208:209], v[168:169], v[158:159], v[208:209]
  v_pk_mul_f32 v[208:209], v[208:209], v[198:199]
  v_lshlrev_b32 v198, 16, v137
  v_and_b32 v199, s16, v137
  v_pk_mul_f32 v[210:211], v[176:177], v[152:153]
  v_pk_fma_f32 v[210:211], v[174:175], v[154:155], v[210:211]
  v_pk_fma_f32 v[210:211], v[172:173], v[156:157], v[210:211]
  v_pk_fma_f32 v[210:211], v[170:171], v[158:159], v[210:211]
  v_pk_mul_f32 v[210:211], v[210:211], v[198:199]
  v_lshlrev_b32 v198, 16, v138
  v_and_b32 v199, s16, v138
  v_pk_mul_f32 v[212:213], v[178:179], v[152:153]
  v_pk_fma_f32 v[212:213], v[176:177], v[154:155], v[212:213]
  v_pk_fma_f32 v[212:213], v[174:175], v[156:157], v[212:213]
  v_pk_fma_f32 v[212:213], v[172:173], v[158:159], v[212:213]
  v_pk_mul_f32 v[212:213], v[212:213], v[198:199]
  v_lshlrev_b32 v198, 16, v139
  v_and_b32 v199, s16, v139
  v_pk_mul_f32 v[214:215], v[180:181], v[152:153]
  v_pk_fma_f32 v[214:215], v[178:179], v[154:155], v[214:215]
  v_pk_fma_f32 v[214:215], v[176:177], v[156:157], v[214:215]
  v_pk_fma_f32 v[214:215], v[174:175], v[158:159], v[214:215]
  v_pk_mul_f32 v[214:215], v[214:215], v[198:199]
  v_lshlrev_b32 v198, 16, v140
  v_and_b32 v199, s16, v140
  v_pk_mul_f32 v[216:217], v[182:183], v[152:153]
  v_pk_fma_f32 v[216:217], v[180:181], v[154:155], v[216:217]
  v_pk_fma_f32 v[216:217], v[178:179], v[156:157], v[216:217]
  v_pk_fma_f32 v[216:217], v[176:177], v[158:159], v[216:217]
  v_pk_mul_f32 v[216:217], v[216:217], v[198:199]
  v_lshlrev_b32 v198, 16, v141
  v_and_b32 v199, s16, v141
  v_pk_mul_f32 v[218:219], v[184:185], v[152:153]
  v_pk_fma_f32 v[218:219], v[182:183], v[154:155], v[218:219]
  v_pk_fma_f32 v[218:219], v[180:181], v[156:157], v[218:219]
  v_pk_fma_f32 v[218:219], v[178:179], v[158:159], v[218:219]
  v_pk_mul_f32 v[218:219], v[218:219], v[198:199]
  v_lshlrev_b32 v198, 16, v142
  v_and_b32 v199, s16, v142
  v_pk_mul_f32 v[220:221], v[186:187], v[152:153]
  v_pk_fma_f32 v[220:221], v[184:185], v[154:155], v[220:221]
  v_pk_fma_f32 v[220:221], v[182:183], v[156:157], v[220:221]
  v_pk_fma_f32 v[220:221], v[180:181], v[158:159], v[220:221]
  v_pk_mul_f32 v[220:221], v[220:221], v[198:199]
  v_lshlrev_b32 v198, 16, v143
  v_and_b32 v199, s16, v143
  v_pk_mul_f32 v[222:223], v[188:189], v[152:153]
  v_pk_fma_f32 v[222:223], v[186:187], v[154:155], v[222:223]
  v_pk_fma_f32 v[222:223], v[184:185], v[156:157], v[222:223]
  v_pk_fma_f32 v[222:223], v[182:183], v[158:159], v[222:223]
  v_pk_mul_f32 v[222:223], v[222:223], v[198:199]
  v_lshlrev_b32 v198, 16, v144
  v_and_b32 v199, s16, v144
  v_pk_mul_f32 v[224:225], v[190:191], v[152:153]
  v_pk_fma_f32 v[224:225], v[188:189], v[154:155], v[224:225]
  v_pk_fma_f32 v[224:225], v[186:187], v[156:157], v[224:225]
  v_pk_fma_f32 v[224:225], v[184:185], v[158:159], v[224:225]
  v_pk_mul_f32 v[224:225], v[224:225], v[198:199]
  v_lshlrev_b32 v198, 16, v145
  v_and_b32 v199, s16, v145
  v_pk_mul_f32 v[226:227], v[192:193], v[152:153]
  v_pk_fma_f32 v[226:227], v[190:191], v[154:155], v[226:227]
  v_pk_fma_f32 v[226:227], v[188:189], v[156:157], v[226:227]
  v_pk_fma_f32 v[226:227], v[186:187], v[158:159], v[226:227]
  v_pk_mul_f32 v[226:227], v[226:227], v[198:199]
  v_lshlrev_b32 v198, 16, v146
  v_and_b32 v199, s16, v146
  v_pk_mul_f32 v[228:229], v[194:195], v[152:153]
  v_pk_fma_f32 v[228:229], v[192:193], v[154:155], v[228:229]
  v_pk_fma_f32 v[228:229], v[190:191], v[156:157], v[228:229]
  v_pk_fma_f32 v[228:229], v[188:189], v[158:159], v[228:229]
  v_pk_mul_f32 v[228:229], v[228:229], v[198:199]
  v_lshlrev_b32 v198, 16, v147
  v_and_b32 v199, s16, v147
  v_pk_mul_f32 v[230:231], v[196:197], v[152:153]
  v_pk_fma_f32 v[230:231], v[194:195], v[154:155], v[230:231]
  v_pk_fma_f32 v[230:231], v[192:193], v[156:157], v[230:231]
  v_pk_fma_f32 v[230:231], v[190:191], v[158:159], v[230:231]
  v_pk_mul_f32 v[230:231], v[230:231], v[198:199]
  v_cvt_pk_bf16_f32 v112, v230, v228
  v_cvt_pk_bf16_f32 v113, v226, v224
  v_cvt_pk_bf16_f32 v114, v222, v220
  v_cvt_pk_bf16_f32 v115, v218, v216
  v_cvt_pk_bf16_f32 v116, v214, v212
  v_cvt_pk_bf16_f32 v117, v210, v208
  v_cvt_pk_bf16_f32 v118, v206, v204
  v_cvt_pk_bf16_f32 v119, v202, v200
  v_cvt_pk_bf16_f32 v120, v231, v229
  v_cvt_pk_bf16_f32 v121, v227, v225
  v_cvt_pk_bf16_f32 v122, v223, v221
  v_cvt_pk_bf16_f32 v123, v219, v217
  v_cvt_pk_bf16_f32 v124, v215, v213
  v_cvt_pk_bf16_f32 v125, v211, v209
  v_cvt_pk_bf16_f32 v126, v207, v205
  v_cvt_pk_bf16_f32 v127, v203, v201
  v_mul_u32_u24 v8, 288, v1
  s_sub_u32 s16, 3, s52
  s_lshl_b32 s16, s16, 5
  s_add_u32 s16, s16, 98304
  v_add_u32 v8, s16, v8
  v_lshrrev_b32 v9, 3, v1
  v_and_b32 v14, 7, v1
  s_mul_i32 s16, s52, 20
  v_add_u32 v9, s16, v9
  v_mul_u32_u24 v15, 144, v9
  v_lshl_add_u32 v15, v14, 4, v15
  v_add_u32 v15, 98304, v15
  v_lshlrev_b32 v9, 12, v9
  v_lshl_add_u32 v9, v14, 4, v9
  s_lshl_b32 s17, s11, 12
  s_lshr_b32 s16, s2, 3
  s_lshl_b32 s16, s16, 7
  s_sub_u32 s16, 8392576, s16
  s_add_u32 s16, s16, s17
  v_mov_b32 v10, 161812
  v_mov_b32 v11, 1
  s_mov_b32 exec_hi, 0xff
  s_barrier
  ds_write_b128 v8, v[112:115]
  ds_write_b128 v8, v[116:119] offset:16
  ds_write_b128 v8, v[120:123] offset:144
  ds_write_b128 v8, v[124:127] offset:160
  s_mov_b64 exec, 1
  s_waitcnt lgkmcnt(0)
  ds_add_u32 v10, v11
  s_mov_b32 s13, 0
K1_XSPIN:
  s_add_u32 s13, s13, 1
  s_cmp_ge_u32 s13, 4194304
  s_cbranch_scc1 K1_XGO
  ds_read_b32 v12, v10
  s_waitcnt lgkmcnt(0)
  v_readfirstlane_b32 s12, v12
  s_cmp_eq_u32 s12, 4
  s_cbranch_scc0 K1_XSPIN
K1_XGO:
  s_mov_b64 exec, -1
  ds_read_b128 v[112:115], v15
  ds_read_b128 v[116:119], v15 offset:1152
  ds_read_b128 v[120:123], v15 offset:2304
  s_waitcnt lgkmcnt(2)
  buffer_store_dwordx4 v[112:115], v9, s[48:51], s16 offen sc1
  s_add_u32 s17, s16, 32768
  s_waitcnt lgkmcnt(1)
  buffer_store_dwordx4 v[116:119], v9, s[48:51], s17 offen sc1
  s_add_u32 s17, s16, 65536
  s_mov_b32 exec_hi, 0
  s_waitcnt lgkmcnt(0)
  buffer_store_dwordx4 v[120:123], v9, s[48:51], s17 offen sc1
  s_mov_b64 exec, -1
K1_END:
  s_endpgm
  .globl k2_kernel
  .p2align 8
  .type k2_kernel,@function
k2_kernel:
  s_cmp_ge_u32 s2, 256
  s_cbranch_scc1 K2_END
  v_lshrrev_b32 v2, 6, v0
  v_and_b32 v1, 63, v0
  s_nop 0
  v_readfirstlane_b32 s52, v2
  s_cmp_ge_u32 s52, 4
  s_cbranch_scc1 K2_CONV
  s_load_dwordx2 s[20:21], s[0:1], 104
  s_load_dwordx2 s[28:29], s[0:1], 0
  s_load_dwordx2 s[40:41], s[0:1], 80
  s_load_dwordx2 s[32:33], s[0:1], 88
  s_mov_b32 s22, 0xe50000
  s_mov_b32 s23, 0x00020000
  s_mov_b32 s30, 0x280000
  s_mov_b32 s31, 0x00020000
  s_mov_b32 s42, 0x500
  s_mov_b32 s43, 0x00020000
  s_mov_b32 s34, 0x280000
  s_mov_b32 s35, 0x00020000
  s_and_b32 s3, s2, 7
  s_lshr_b32 s4, s2, 3
  s_and_b32 s5, s3, 3
  s_lshl_b32 s5, s5, 3
  s_and_b32 s6, s4, 7
  s_add_u32 s55, s5, s6
  s_lshr_b32 s5, s3, 2
  s_lshl_b32 s5, s5, 2
  s_lshr_b32 s6, s4, 3
  s_add_u32 s56, s5, s6
  s_mul_i32 s5, s55, 48
  s_mul_i32 s6, s52, 12
  s_add_u32 s5, s5, s6
  s_lshl_b32 s57, s5, 12
  s_mul_i32 s5, s56, 48
  s_add_u32 s5, s5, s6
  s_mul_i32 s58, s5, 5120
  s_add_u32 s58, s58, 6291456
  v_lshlrev_b32 v6, 4, v1
  v_add_u32 v7, 4096, v6
  s_add_u32 s5, s52, 0
  s_and_b32 s5, s5, 3
  s_lshl_b32 s5, s5, 10
  v_add_u32 v2, s5, v6
  s_add_u32 s5, s52, 1
  s_and_b32 s5, s5, 3
  s_lshl_b32 s5, s5, 10
  v_add_u32 v3, s5, v6
  s_add_u32 s5, s52, 2
  s_and_b32 s5, s5, 3
  s_lshl_b32 s5, s5, 10
  v_add_u32 v4, s5, v6
  s_add_u32 s5, s52, 3
  s_and_b32 s5, s5, 3
  s_lshl_b32 s5, s5, 10
  v_add_u32 v5, s5, v6
  s_waitcnt lgkmcnt(0)
  s_barrier
  buffer_load_dwordx4 v[32:35], v2, s[20:23], s57 offen
  buffer_load_dwordx4 v[36:39], v3, s[20:23], s57 offen
  buffer_load_dwordx4 v[40:43], v4, s[20:23], s57 offen
  buffer_load_dwordx4 v[44:47], v5, s[20:23], s57 offen
  buffer_load_dwordx4 v[48:51], v6, s[20:23], s58 offen offset:0
  buffer_load_dwordx4 v[52:55], v6, s[20:23], s58 offen offset:1024
  buffer_load_dwordx4 v[56:59], v6, s[20:23], s58 offen offset:2048
  buffer_load_dwordx4 v[60:63], v6, s[20:23], s58 offen offset:3072
  buffer_load_dwordx4 v[64:67], v7, s[20:23], s58 offen
  s_add_u32 s57, s57, 4096
  s_add_u32 s58, s58, 5120
  buffer_load_dwordx4 v[68:71], v2, s[20:23], s57 offen
  buffer_load_dwordx4 v[72:75], v3, s[20:23], s57 offen
  buffer_load_dwordx4 v[76:79], v4, s[20:23], s57 offen
  buffer_load_dwordx4 v[80:83], v5, s[20:23], s57 offen
  buffer_load_dwordx4 v[84:87], v6, s[20:23], s58 offen offset:0
  buffer_load_dwordx4 v[88:91], v6, s[20:23], s58 offen offset:1024
  buffer_load_dwordx4 v[92:95], v6, s[20:23], s58 offen offset:2048
  buffer_load_dwordx4 v[96:99], v6, s[20:23], s58 offen offset:3072
  buffer_load_dwordx4 v[100:103], v7, s[20:23], s58 offen
  s_add_u32 s57, s57, 4096
  s_add_u32 s58, s58, 5120
  buffer_load_dwordx4 v[104:107], v2, s[20:23], s57 offen
  buffer_load_dwordx4 v[108:111], v3, s[20:23], s57 offen
  buffer_load_dwordx4 v[112:115], v4, s[20:23], s57 offen
  buffer_load_dwordx4 v[116:119], v5, s[20:23], s57 offen
  buffer_load_dwordx4 v[120:123], v6, s[20:23], s58 offen offset:0
  buffer_load_dwordx4 v[124:127], v6, s[20:23], s58 offen offset:1024
  buffer_load_dwordx4 v[128:131], v6, s[20:23], s58 offen offset:2048
  buffer_load_dwordx4 v[132:135], v6, s[20:23], s58 offen offset:3072
  buffer_load_dwordx4 v[136:139], v7, s[20:23], s58 offen
  s_add_u32 s57, s57, 4096
  s_add_u32 s58, s58, 5120
  s_lshl_b32 s59, s55, 6
  s_lshl_b32 s5, s52, 4
  s_add_u32 s59, s59, s5
  s_mul_i32 s6, s59, 1280
  s_mul_i32 s7, s56, 160
  s_add_u32 s6, s6, s7
  s_mul_i32 s8, s52, 3072
  s_add_u32 s8, s8, 148480
  v_add_u32 v26, 0, v1
  v_mul_u32_u24 v27, 6554, v26
  v_lshrrev_b32 v27, 16, v27
  v_mul_u32_u24 v28, 10, v27
  v_sub_u32 v28, v26, v28
  v_mul_u32_u24 v27, 1280, v27
  v_lshl_add_u32 v27, v28, 4, v27
  v_add_u32 v8, s6, v27
  s_add_u32 m0, s8, 0
  s_nop 0
  buffer_load_dwordx4 v8, s[28:31], 0 offen lds
  v_add_u32 v26, 64, v1
  v_mul_u32_u24 v27, 6554, v26
  v_lshrrev_b32 v27, 16, v27
  v_mul_u32_u24 v28, 10, v27
  v_sub_u32 v28, v26, v28
  v_mul_u32_u24 v27, 1280, v27
  v_lshl_add_u32 v27, v28, 4, v27
  v_add_u32 v9, s6, v27
  s_add_u32 m0, s8, 1024
  s_nop 0
  buffer_load_dwordx4 v9, s[28:31], 0 offen lds
  v_add_u32 v26, 128, v1
  v_mul_u32_u24 v27, 6554, v26
  v_lshrrev_b32 v27, 16, v27
  v_mul_u32_u24 v28, 10, v27
  v_sub_u32 v28, v26, v28
  v_mul_u32_u24 v27, 1280, v27
  v_lshl_add_u32 v27, v28, 4, v27
  v_add_u32 v10, s6, v27
  v_mov_b32 v27, 0x7ffffff0
  v_cmp_gt_u32 vcc, 32, v1
  v_cndmask_b32 v10, v27, v10, vcc
  s_add_u32 m0, s8, 2048
  s_nop 0
  buffer_load_dwordx4 v10, s[28:31], 0 offen lds
  v_and_b32 v26, 15, v1
  v_lshrrev_b32 v27, 4, v1
  s_lshl_b32 s6, s59, 3
  s_add_u32 s9, s6, 14680064
  v_lshlrev_b32 v28, 3, v26
  buffer_load_dwordx2 v[12:13], v28, s[20:23], s9 offen
  v_lshl_add_u32 v24, v27, 14, v28
  s_mul_i32 s7, s56, 327680
  s_add_u32 s6, s6, s7
  s_add_u32 s10, s6, 11534336
  v_lshlrev_b32 v29, 3, v27
  s_mul_i32 s7, s56, 160
  buffer_load_dwordx2 v[14:15], v29, s[40:43], s7 offen offset:0
  buffer_load_dwordx2 v[16:17], v29, s[40:43], s7 offen offset:32
  buffer_load_dwordx2 v[18:19], v29, s[40:43], s7 offen offset:64
  buffer_load_dwordx2 v[20:21], v29, s[40:43], s7 offen offset:96
  buffer_load_dwordx2 v[22:23], v29, s[40:43], s7 offen offset:128
  s_lshl_b32 s11, s56, 5
  s_add_u32 s11, s11, s55
  s_lshl_b32 s11, s11, 7
  s_add_u32 s11, s11, 14712832
  v_min_u32 v25, 19, v1
  v_lshlrev_b32 v25, 2, v25
  buffer_load_dwordx4 v[140:143], v2, s[20:23], s57 offen
  buffer_load_dwordx4 v[144:147], v3, s[20:23], s57 offen
  buffer_load_dwordx4 v[148:151], v4, s[20:23], s57 offen
  buffer_load_dwordx4 v[152:155], v5, s[20:23], s57 offen
  buffer_load_dwordx4 v[156:159], v6, s[20:23], s58 offen offset:0
  buffer_load_dwordx4 v[160:163], v6, s[20:23], s58 offen offset:1024
  buffer_load_dwordx4 v[164:167], v6, s[20:23], s58 offen offset:2048
  buffer_load_dwordx4 v[168:171], v6, s[20:23], s58 offen offset:3072
  buffer_load_dwordx4 v[172:175], v7, s[20:23], s58 offen
  s_add_u32 s57, s57, 4096
  s_add_u32 s58, s58, 5120
  s_waitcnt vmcnt(36)
  v_mfma_f32_16x16x32_bf16 v[176:179], v[48:51], v[32:35], 0
  v_mfma_f32_16x16x32_bf16 v[196:199], v[48:51], v[36:39], 0
  v_mfma_f32_16x16x32_bf16 v[216:219], v[48:51], v[40:43], 0
  v_mfma_f32_16x16x32_bf16 v[236:239], v[48:51], v[44:47], 0
  v_mfma_f32_16x16x32_bf16 v[180:183], v[52:55], v[32:35], 0
  v_mfma_f32_16x16x32_bf16 v[200:203], v[52:55], v[36:39], 0
  v_mfma_f32_16x16x32_bf16 v[220:223], v[52:55], v[40:43], 0
  v_mfma_f32_16x16x32_bf16 v[240:243], v[52:55], v[44:47], 0
  v_mfma_f32_16x16x32_bf16 v[184:187], v[56:59], v[32:35], 0
  v_mfma_f32_16x16x32_bf16 v[204:207], v[56:59], v[36:39], 0
  v_mfma_f32_16x16x32_bf16 v[224:227], v[56:59], v[40:43], 0
  v_mfma_f32_16x16x32_bf16 v[244:247], v[56:59], v[44:47], 0
  v_mfma_f32_16x16x32_bf16 v[188:191], v[60:63], v[32:35], 0
  v_mfma_f32_16x16x32_bf16 v[208:211], v[60:63], v[36:39], 0
  v_mfma_f32_16x16x32_bf16 v[228:231], v[60:63], v[40:43], 0
  v_mfma_f32_16x16x32_bf16 v[248:251], v[60:63], v[44:47], 0
  v_mfma_f32_16x16x32_bf16 v[192:195], v[64:67], v[32:35], 0
  v_mfma_f32_16x16x32_bf16 v[212:215], v[64:67], v[36:39], 0
  v_mfma_f32_16x16x32_bf16 v[232:235], v[64:67], v[40:43], 0
  v_mfma_f32_16x16x32_bf16 v[252:255], v[64:67], v[44:47], 0
  buffer_load_dwordx4 v[32:35], v2, s[20:23], s57 offen
  buffer_load_dwordx4 v[36:39], v3, s[20:23], s57 offen
  buffer_load_dwordx4 v[40:43], v4, s[20:23], s57 offen
  buffer_load_dwordx4 v[44:47], v5, s[20:23], s57 offen
  buffer_load_dwordx4 v[48:51], v6, s[20:23], s58 offen offset:0
  buffer_load_dwordx4 v[52:55], v6, s[20:23], s58 offen offset:1024
  buffer_load_dwordx4 v[56:59], v6, s[20:23], s58 offen offset:2048
  buffer_load_dwordx4 v[60:63], v6, s[20:23], s58 offen offset:3072
  buffer_load_dwordx4 v[64:67], v7, s[20:23], s58 offen
  s_add_u32 s57, s57, 4096
  s_add_u32 s58, s58, 5120
  s_waitcnt vmcnt(36)
  v_mfma_f32_16x16x32_bf16 v[176:179], v[84:87], v[68:71], v[176:179]
  v_mfma_f32_16x16x32_bf16 v[196:199], v[84:87], v[72:75], v[196:199]
  v_mfma_f32_16x16x32_bf16 v[216:219], v[84:87], v[76:79], v[216:219]
  v_mfma_f32_16x16x32_bf16 v[236:239], v[84:87], v[80:83], v[236:239]
  v_mfma_f32_16x16x32_bf16 v[180:183], v[88:91], v[68:71], v[180:183]
  v_mfma_f32_16x16x32_bf16 v[200:203], v[88:91], v[72:75], v[200:203]
  v_mfma_f32_16x16x32_bf16 v[220:223], v[88:91], v[76:79], v[220:223]
  v_mfma_f32_16x16x32_bf16 v[240:243], v[88:91], v[80:83], v[240:243]
  v_mfma_f32_16x16x32_bf16 v[184:187], v[92:95], v[68:71], v[184:187]
  v_mfma_f32_16x16x32_bf16 v[204:207], v[92:95], v[72:75], v[204:207]
  v_mfma_f32_16x16x32_bf16 v[224:227], v[92:95], v[76:79], v[224:227]
  v_mfma_f32_16x16x32_bf16 v[244:247], v[92:95], v[80:83], v[244:247]
  v_mfma_f32_16x16x32_bf16 v[188:191], v[96:99], v[68:71], v[188:191]
  v_mfma_f32_16x16x32_bf16 v[208:211], v[96:99], v[72:75], v[208:211]
  v_mfma_f32_16x16x32_bf16 v[228:231], v[96:99], v[76:79], v[228:231]
  v_mfma_f32_16x16x32_bf16 v[248:251], v[96:99], v[80:83], v[248:251]
  v_mfma_f32_16x16x32_bf16 v[192:195], v[100:103], v[68:71], v[192:195]
  v_mfma_f32_16x16x32_bf16 v[212:215], v[100:103], v[72:75], v[212:215]
  v_mfma_f32_16x16x32_bf16 v[232:235], v[100:103], v[76:79], v[232:235]
  v_mfma_f32_16x16x32_bf16 v[252:255], v[100:103], v[80:83], v[252:255]
  buffer_load_dwordx4 v[68:71], v2, s[20:23], s57 offen
  buffer_load_dwordx4 v[72:75], v3, s[20:23], s57 offen
  buffer_load_dwordx4 v[76:79], v4, s[20:23], s57 offen
  buffer_load_dwordx4 v[80:83], v5, s[20:23], s57 offen
  buffer_load_dwordx4 v[84:87], v6, s[20:23], s58 offen offset:0
  buffer_load_dwordx4 v[88:91], v6, s[20:23], s58 offen offset:1024
  buffer_load_dwordx4 v[92:95], v6, s[20:23], s58 offen offset:2048
  buffer_load_dwordx4 v[96:99], v6, s[20:23], s58 offen offset:3072
  buffer_load_dwordx4 v[100:103], v7, s[20:23], s58 offen
  s_add_u32 s57, s57, 4096
  s_add_u32 s58, s58, 5120
  s_waitcnt vmcnt(36)
  v_mfma_f32_16x16x32_bf16 v[176:179], v[120:123], v[104:107], v[176:179]
  v_mfma_f32_16x16x32_bf16 v[196:199], v[120:123], v[108:111], v[196:199]
  v_mfma_f32_16x16x32_bf16 v[216:219], v[120:123], v[112:115], v[216:219]
  v_mfma_f32_16x16x32_bf16 v[236:239], v[120:123], v[116:119], v[236:239]
  v_mfma_f32_16x16x32_bf16 v[180:183], v[124:127], v[104:107], v[180:183]
  v_mfma_f32_16x16x32_bf16 v[200:203], v[124:127], v[108:111], v[200:203]
  v_mfma_f32_16x16x32_bf16 v[220:223], v[124:127], v[112:115], v[220:223]
  v_mfma_f32_16x16x32_bf16 v[240:243], v[124:127], v[116:119], v[240:243]
  v_mfma_f32_16x16x32_bf16 v[184:187], v[128:131], v[104:107], v[184:187]
  v_mfma_f32_16x16x32_bf16 v[204:207], v[128:131], v[108:111], v[204:207]
  v_mfma_f32_16x16x32_bf16 v[224:227], v[128:131], v[112:115], v[224:227]
  v_mfma_f32_16x16x32_bf16 v[244:247], v[128:131], v[116:119], v[244:247]
  v_mfma_f32_16x16x32_bf16 v[188:191], v[132:135], v[104:107], v[188:191]
  v_mfma_f32_16x16x32_bf16 v[208:211], v[132:135], v[108:111], v[208:211]
  v_mfma_f32_16x16x32_bf16 v[228:231], v[132:135], v[112:115], v[228:231]
  v_mfma_f32_16x16x32_bf16 v[248:251], v[132:135], v[116:119], v[248:251]
  v_mfma_f32_16x16x32_bf16 v[192:195], v[136:139], v[104:107], v[192:195]
  v_mfma_f32_16x16x32_bf16 v[212:215], v[136:139], v[108:111], v[212:215]
  v_mfma_f32_16x16x32_bf16 v[232:235], v[136:139], v[112:115], v[232:235]
  v_mfma_f32_16x16x32_bf16 v[252:255], v[136:139], v[116:119], v[252:255]
  buffer_load_dwordx4 v[104:107], v2, s[20:23], s57 offen
  buffer_load_dwordx4 v[108:111], v3, s[20:23], s57 offen
  buffer_load_dwordx4 v[112:115], v4, s[20:23], s57 offen
  buffer_load_dwordx4 v[116:119], v5, s[20:23], s57 offen
  buffer_load_dwordx4 v[120:123], v6, s[20:23], s58 offen offset:0
  buffer_load_dwordx4 v[124:127], v6, s[20:23], s58 offen offset:1024
  buffer_load_dwordx4 v[128:131], v6, s[20:23], s58 offen offset:2048
  buffer_load_dwordx4 v[132:135], v6, s[20:23], s58 offen offset:3072
  buffer_load_dwordx4 v[136:139], v7, s[20:23], s58 offen
  s_add_u32 s57, s57, 4096
  s_add_u32 s58, s58, 5120
  s_waitcnt vmcnt(27)
  v_mfma_f32_16x16x32_bf16 v[176:179], v[156:159], v[140:143], v[176:179]
  v_mfma_f32_16x16x32_bf16 v[196:199], v[156:159], v[144:147], v[196:199]
  v_mfma_f32_16x16x32_bf16 v[216:219], v[156:159], v[148:151], v[216:219]
  v_mfma_f32_16x16x32_bf16 v[236:239], v[156:159], v[152:155], v[236:239]
  v_mfma_f32_16x16x32_bf16 v[180:183], v[160:163], v[140:143], v[180:183]
  v_mfma_f32_16x16x32_bf16 v[200:203], v[160:163], v[144:147], v[200:203]
  v_mfma_f32_16x16x32_bf16 v[220:223], v[160:163], v[148:151], v[220:223]
  v_mfma_f32_16x16x32_bf16 v[240:243], v[160:163], v[152:155], v[240:243]
  v_mfma_f32_16x16x32_bf16 v[184:187], v[164:167], v[140:143], v[184:187]
  v_mfma_f32_16x16x32_bf16 v[204:207], v[164:167], v[144:147], v[204:207]
  v_mfma_f32_16x16x32_bf16 v[224:227], v[164:167], v[148:151], v[224:227]
  v_mfma_f32_16x16x32_bf16 v[244:247], v[164:167], v[152:155], v[244:247]
  v_mfma_f32_16x16x32_bf16 v[188:191], v[168:171], v[140:143], v[188:191]
  v_mfma_f32_16x16x32_bf16 v[208:211], v[168:171], v[144:147], v[208:211]
  v_mfma_f32_16x16x32_bf16 v[228:231], v[168:171], v[148:151], v[228:231]
  v_mfma_f32_16x16x32_bf16 v[248:251], v[168:171], v[152:155], v[248:251]
  v_mfma_f32_16x16x32_bf16 v[192:195], v[172:175], v[140:143], v[192:195]
  v_mfma_f32_16x16x32_bf16 v[212:215], v[172:175], v[144:147], v[212:215]
  v_mfma_f32_16x16x32_bf16 v[232:235], v[172:175], v[148:151], v[232:235]
  v_mfma_f32_16x16x32_bf16 v[252:255], v[172:175], v[152:155], v[252:255]
  buffer_load_dwordx4 v[140:143], v2, s[20:23], s57 offen
  buffer_load_dwordx4 v[144:147], v3, s[20:23], s57 offen
  buffer_load_dwordx4 v[148:151], v4, s[20:23], s57 offen
  buffer_load_dwordx4 v[152:155], v5, s[20:23], s57 offen
  buffer_load_dwordx4 v[156:159], v6, s[20:23], s58 offen offset:0
  buffer_load_dwordx4 v[160:163], v6, s[20:23], s58 offen offset:1024
  buffer_load_dwordx4 v[164:167], v6, s[20:23], s58 offen offset:2048
  buffer_load_dwordx4 v[168:171], v6, s[20:23], s58 offen offset:3072
  buffer_load_dwordx4 v[172:175], v7, s[20:23], s58 offen
  s_add_u32 s57, s57, 4096
  s_add_u32 s58, s58, 5120
  s_waitcnt vmcnt(27)
  v_mfma_f32_16x16x32_bf16 v[176:179], v[48:51], v[32:35], v[176:179]
  v_mfma_f32_16x16x32_bf16 v[196:199], v[48:51], v[36:39], v[196:199]
  v_mfma_f32_16x16x32_bf16 v[216:219], v[48:51], v[40:43], v[216:219]
  v_mfma_f32_16x16x32_bf16 v[236:239], v[48:51], v[44:47], v[236:239]
  v_mfma_f32_16x16x32_bf16 v[180:183], v[52:55], v[32:35], v[180:183]
  v_mfma_f32_16x16x32_bf16 v[200:203], v[52:55], v[36:39], v[200:203]
  v_mfma_f32_16x16x32_bf16 v[220:223], v[52:55], v[40:43], v[220:223]
  v_mfma_f32_16x16x32_bf16 v[240:243], v[52:55], v[44:47], v[240:243]
  v_mfma_f32_16x16x32_bf16 v[184:187], v[56:59], v[32:35], v[184:187]
  v_mfma_f32_16x16x32_bf16 v[204:207], v[56:59], v[36:39], v[204:207]
  v_mfma_f32_16x16x32_bf16 v[224:227], v[56:59], v[40:43], v[224:227]
  v_mfma_f32_16x16x32_bf16 v[244:247], v[56:59], v[44:47], v[244:247]
  v_mfma_f32_16x16x32_bf16 v[188:191], v[60:63], v[32:35], v[188:191]
  v_mfma_f32_16x16x32_bf16 v[208:211], v[60:63], v[36:39], v[208:211]
  v_mfma_f32_16x16x32_bf16 v[228:231], v[60:63], v[40:43], v[228:231]
  v_mfma_f32_16x16x32_bf16 v[248:251], v[60:63], v[44:47], v[248:251]
  v_mfma_f32_16x16x32_bf16 v[192:195], v[64:67], v[32:35], v[192:195]
  v_mfma_f32_16x16x32_bf16 v[212:215], v[64:67], v[36:39], v[212:215]
  v_mfma_f32_16x16x32_bf16 v[232:235], v[64:67], v[40:43], v[232:235]
  v_mfma_f32_16x16x32_bf16 v[252:255], v[64:67], v[44:47], v[252:255]
  buffer_load_dwordx4 v[32:35], v2, s[20:23], s57 offen
  buffer_load_dwordx4 v[36:39], v3, s[20:23], s57 offen
  buffer_load_dwordx4 v[40:43], v4, s[20:23], s57 offen
  buffer_load_dwordx4 v[44:47], v5, s[20:23], s57 offen
  buffer_load_dwordx4 v[48:51], v6, s[20:23], s58 offen offset:0
  buffer_load_dwordx4 v[52:55], v6, s[20:23], s58 offen offset:1024
  buffer_load_dwordx4 v[56:59], v6, s[20:23], s58 offen offset:2048
  buffer_load_dwordx4 v[60:63], v6, s[20:23], s58 offen offset:3072
  buffer_load_dwordx4 v[64:67], v7, s[20:23], s58 offen
  s_add_u32 s57, s57, 4096
  s_add_u32 s58, s58, 5120
  s_waitcnt vmcnt(27)
  v_mfma_f32_16x16x32_bf16 v[176:179], v[84:87], v[68:71], v[176:179]
  v_mfma_f32_16x16x32_bf16 v[196:199], v[84:87], v[72:75], v[196:199]
  v_mfma_f32_16x16x32_bf16 v[216:219], v[84:87], v[76:79], v[216:219]
  v_mfma_f32_16x16x32_bf16 v[236:239], v[84:87], v[80:83], v[236:239]
  v_mfma_f32_16x16x32_bf16 v[180:183], v[88:91], v[68:71], v[180:183]
  v_mfma_f32_16x16x32_bf16 v[200:203], v[88:91], v[72:75], v[200:203]
  v_mfma_f32_16x16x32_bf16 v[220:223], v[88:91], v[76:79], v[220:223]
  v_mfma_f32_16x16x32_bf16 v[240:243], v[88:91], v[80:83], v[240:243]
  v_mfma_f32_16x16x32_bf16 v[184:187], v[92:95], v[68:71], v[184:187]
  v_mfma_f32_16x16x32_bf16 v[204:207], v[92:95], v[72:75], v[204:207]
  v_mfma_f32_16x16x32_bf16 v[224:227], v[92:95], v[76:79], v[224:227]
  v_mfma_f32_16x16x32_bf16 v[244:247], v[92:95], v[80:83], v[244:247]
  v_mfma_f32_16x16x32_bf16 v[188:191], v[96:99], v[68:71], v[188:191]
  v_mfma_f32_16x16x32_bf16 v[208:211], v[96:99], v[72:75], v[208:211]
  v_mfma_f32_16x16x32_bf16 v[228:231], v[96:99], v[76:79], v[228:231]
  v_mfma_f32_16x16x32_bf16 v[248:251], v[96:99], v[80:83], v[248:251]
  v_mfma_f32_16x16x32_bf16 v[192:195], v[100:103], v[68:71], v[192:195]
  v_mfma_f32_16x16x32_bf16 v[212:215], v[100:103], v[72:75], v[212:215]
  v_mfma_f32_16x16x32_bf16 v[232:235], v[100:103], v[76:79], v[232:235]
  v_mfma_f32_16x16x32_bf16 v[252:255], v[100:103], v[80:83], v[252:255]
  buffer_load_dwordx4 v[68:71], v2, s[20:23], s57 offen
  buffer_load_dwordx4 v[72:75], v3, s[20:23], s57 offen
  buffer_load_dwordx4 v[76:79], v4, s[20:23], s57 offen
  buffer_load_dwordx4 v[80:83], v5, s[20:23], s57 offen
  buffer_load_dwordx4 v[84:87], v6, s[20:23], s58 offen offset:0
  buffer_load_dwordx4 v[88:91], v6, s[20:23], s58 offen offset:1024
  buffer_load_dwordx4 v[92:95], v6, s[20:23], s58 offen offset:2048
  buffer_load_dwordx4 v[96:99], v6, s[20:23], s58 offen offset:3072
  buffer_load_dwordx4 v[100:103], v7, s[20:23], s58 offen
  s_add_u32 s57, s57, 4096
  s_add_u32 s58, s58, 5120
  s_waitcnt vmcnt(27)
  v_mfma_f32_16x16x32_bf16 v[176:179], v[120:123], v[104:107], v[176:179]
  v_mfma_f32_16x16x32_bf16 v[196:199], v[120:123], v[108:111], v[196:199]
  v_mfma_f32_16x16x32_bf16 v[216:219], v[120:123], v[112:115], v[216:219]
  v_mfma_f32_16x16x32_bf16 v[236:239], v[120:123], v[116:119], v[236:239]
  v_mfma_f32_16x16x32_bf16 v[180:183], v[124:127], v[104:107], v[180:183]
  v_mfma_f32_16x16x32_bf16 v[200:203], v[124:127], v[108:111], v[200:203]
  v_mfma_f32_16x16x32_bf16 v[220:223], v[124:127], v[112:115], v[220:223]
  v_mfma_f32_16x16x32_bf16 v[240:243], v[124:127], v[116:119], v[240:243]
  v_mfma_f32_16x16x32_bf16 v[184:187], v[128:131], v[104:107], v[184:187]
  v_mfma_f32_16x16x32_bf16 v[204:207], v[128:131], v[108:111], v[204:207]
  v_mfma_f32_16x16x32_bf16 v[224:227], v[128:131], v[112:115], v[224:227]
  v_mfma_f32_16x16x32_bf16 v[244:247], v[128:131], v[116:119], v[244:247]
  v_mfma_f32_16x16x32_bf16 v[188:191], v[132:135], v[104:107], v[188:191]
  v_mfma_f32_16x16x32_bf16 v[208:211], v[132:135], v[108:111], v[208:211]
  v_mfma_f32_16x16x32_bf16 v[228:231], v[132:135], v[112:115], v[228:231]
  v_mfma_f32_16x16x32_bf16 v[248:251], v[132:135], v[116:119], v[248:251]
  v_mfma_f32_16x16x32_bf16 v[192:195], v[136:139], v[104:107], v[192:195]
  v_mfma_f32_16x16x32_bf16 v[212:215], v[136:139], v[108:111], v[212:215]
  v_mfma_f32_16x16x32_bf16 v[232:235], v[136:139], v[112:115], v[232:235]
  v_mfma_f32_16x16x32_bf16 v[252:255], v[136:139], v[116:119], v[252:255]
  buffer_load_dwordx4 v[104:107], v2, s[20:23], s57 offen
  buffer_load_dwordx4 v[108:111], v3, s[20:23], s57 offen
  buffer_load_dwordx4 v[112:115], v4, s[20:23], s57 offen
  buffer_load_dwordx4 v[116:119], v5, s[20:23], s57 offen
  buffer_load_dwordx4 v[120:123], v6, s[20:23], s58 offen offset:0
  buffer_load_dwordx4 v[124:127], v6, s[20:23], s58 offen offset:1024
  buffer_load_dwordx4 v[128:131], v6, s[20:23], s58 offen offset:2048
  buffer_load_dwordx4 v[132:135], v6, s[20:23], s58 offen offset:3072
  buffer_load_dwordx4 v[136:139], v7, s[20:23], s58 offen
  s_add_u32 s57, s57, 4096
  s_add_u32 s58, s58, 5120
  s_waitcnt vmcnt(27)
  v_mfma_f32_16x16x32_bf16 v[176:179], v[156:159], v[140:143], v[176:179]
  v_mfma_f32_16x16x32_bf16 v[196:199], v[156:159], v[144:147], v[196:199]
  v_mfma_f32_16x16x32_bf16 v[216:219], v[156:159], v[148:151], v[216:219]
  v_mfma_f32_16x16x32_bf16 v[236:239], v[156:159], v[152:155], v[236:239]
  v_mfma_f32_16x16x32_bf16 v[180:183], v[160:163], v[140:143], v[180:183]
  v_mfma_f32_16x16x32_bf16 v[200:203], v[160:163], v[144:147], v[200:203]
  v_mfma_f32_16x16x32_bf16 v[220:223], v[160:163], v[148:151], v[220:223]
  v_mfma_f32_16x16x32_bf16 v[240:243], v[160:163], v[152:155], v[240:243]
  v_mfma_f32_16x16x32_bf16 v[184:187], v[164:167], v[140:143], v[184:187]
  v_mfma_f32_16x16x32_bf16 v[204:207], v[164:167], v[144:147], v[204:207]
  v_mfma_f32_16x16x32_bf16 v[224:227], v[164:167], v[148:151], v[224:227]
  v_mfma_f32_16x16x32_bf16 v[244:247], v[164:167], v[152:155], v[244:247]
  v_mfma_f32_16x16x32_bf16 v[188:191], v[168:171], v[140:143], v[188:191]
  v_mfma_f32_16x16x32_bf16 v[208:211], v[168:171], v[144:147], v[208:211]
  v_mfma_f32_16x16x32_bf16 v[228:231], v[168:171], v[148:151], v[228:231]
  v_mfma_f32_16x16x32_bf16 v[248:251], v[168:171], v[152:155], v[248:251]
  v_mfma_f32_16x16x32_bf16 v[192:195], v[172:175], v[140:143], v[192:195]
  v_mfma_f32_16x16x32_bf16 v[212:215], v[172:175], v[144:147], v[212:215]
  v_mfma_f32_16x16x32_bf16 v[232:235], v[172:175], v[148:151], v[232:235]
  v_mfma_f32_16x16x32_bf16 v[252:255], v[172:175], v[152:155], v[252:255]
  buffer_load_dwordx4 v[140:143], v2, s[20:23], s57 offen
  buffer_load_dwordx4 v[144:147], v3, s[20:23], s57 offen
  buffer_load_dwordx4 v[148:151], v4, s[20:23], s57 offen
  buffer_load_dwordx4 v[152:155], v5, s[20:23], s57 offen
  buffer_load_dwordx4 v[156:159], v6, s[20:23], s58 offen offset:0
  buffer_load_dwordx4 v[160:163], v6, s[20:23], s58 offen offset:1024
  buffer_load_dwordx4 v[164:167], v6, s[20:23], s58 offen offset:2048
  buffer_load_dwordx4 v[168:171], v6, s[20:23], s58 offen offset:3072
  buffer_load_dwordx4 v[172:175], v7, s[20:23], s58 offen
  s_add_u32 s57, s57, 4096
  s_add_u32 s58, s58, 5120
  s_waitcnt vmcnt(27)
  v_mfma_f32_16x16x32_bf16 v[176:179], v[48:51], v[32:35], v[176:179]
  v_mfma_f32_16x16x32_bf16 v[196:199], v[48:51], v[36:39], v[196:199]
  v_mfma_f32_16x16x32_bf16 v[216:219], v[48:51], v[40:43], v[216:219]
  v_mfma_f32_16x16x32_bf16 v[236:239], v[48:51], v[44:47], v[236:239]
  v_mfma_f32_16x16x32_bf16 v[180:183], v[52:55], v[32:35], v[180:183]
  v_mfma_f32_16x16x32_bf16 v[200:203], v[52:55], v[36:39], v[200:203]
  v_mfma_f32_16x16x32_bf16 v[220:223], v[52:55], v[40:43], v[220:223]
  v_mfma_f32_16x16x32_bf16 v[240:243], v[52:55], v[44:47], v[240:243]
  v_mfma_f32_16x16x32_bf16 v[184:187], v[56:59], v[32:35], v[184:187]
  v_mfma_f32_16x16x32_bf16 v[204:207], v[56:59], v[36:39], v[204:207]
  v_mfma_f32_16x16x32_bf16 v[224:227], v[56:59], v[40:43], v[224:227]
  v_mfma_f32_16x16x32_bf16 v[244:247], v[56:59], v[44:47], v[244:247]
  v_mfma_f32_16x16x32_bf16 v[188:191], v[60:63], v[32:35], v[188:191]
  v_mfma_f32_16x16x32_bf16 v[208:211], v[60:63], v[36:39], v[208:211]
  v_mfma_f32_16x16x32_bf16 v[228:231], v[60:63], v[40:43], v[228:231]
  v_mfma_f32_16x16x32_bf16 v[248:251], v[60:63], v[44:47], v[248:251]
  v_mfma_f32_16x16x32_bf16 v[192:195], v[64:67], v[32:35], v[192:195]
  v_mfma_f32_16x16x32_bf16 v[212:215], v[64:67], v[36:39], v[212:215]
  v_mfma_f32_16x16x32_bf16 v[232:235], v[64:67], v[40:43], v[232:235]
  v_mfma_f32_16x16x32_bf16 v[252:255], v[64:67], v[44:47], v[252:255]
  buffer_load_dword v28, v25, s[20:23], s11 offen sc1
  s_waitcnt vmcnt(19)
  v_mfma_f32_16x16x32_bf16 v[176:179], v[84:87], v[68:71], v[176:179]
  v_mfma_f32_16x16x32_bf16 v[196:199], v[84:87], v[72:75], v[196:199]
  v_mfma_f32_16x16x32_bf16 v[216:219], v[84:87], v[76:79], v[216:219]
  v_mfma_f32_16x16x32_bf16 v[236:239], v[84:87], v[80:83], v[236:239]
  v_mfma_f32_16x16x32_bf16 v[180:183], v[88:91], v[68:71], v[180:183]
  v_mfma_f32_16x16x32_bf16 v[200:203], v[88:91], v[72:75], v[200:203]
  v_mfma_f32_16x16x32_bf16 v[220:223], v[88:91], v[76:79], v[220:223]
  v_mfma_f32_16x16x32_bf16 v[240:243], v[88:91], v[80:83], v[240:243]
  v_mfma_f32_16x16x32_bf16 v[184:187], v[92:95], v[68:71], v[184:187]
  v_mfma_f32_16x16x32_bf16 v[204:207], v[92:95], v[72:75], v[204:207]
  v_mfma_f32_16x16x32_bf16 v[224:227], v[92:95], v[76:79], v[224:227]
  v_mfma_f32_16x16x32_bf16 v[244:247], v[92:95], v[80:83], v[244:247]
  v_mfma_f32_16x16x32_bf16 v[188:191], v[96:99], v[68:71], v[188:191]
  v_mfma_f32_16x16x32_bf16 v[208:211], v[96:99], v[72:75], v[208:211]
  v_mfma_f32_16x16x32_bf16 v[228:231], v[96:99], v[76:79], v[228:231]
  v_mfma_f32_16x16x32_bf16 v[248:251], v[96:99], v[80:83], v[248:251]
  v_mfma_f32_16x16x32_bf16 v[192:195], v[100:103], v[68:71], v[192:195]
  v_mfma_f32_16x16x32_bf16 v[212:215], v[100:103], v[72:75], v[212:215]
  v_mfma_f32_16x16x32_bf16 v[232:235], v[100:103], v[76:79], v[232:235]
  v_mfma_f32_16x16x32_bf16 v[252:255], v[100:103], v[80:83], v[252:255]
  s_waitcnt vmcnt(10)
  v_mfma_f32_16x16x32_bf16 v[176:179], v[120:123], v[104:107], v[176:179]
  v_mfma_f32_16x16x32_bf16 v[196:199], v[120:123], v[108:111], v[196:199]
  v_mfma_f32_16x16x32_bf16 v[216:219], v[120:123], v[112:115], v[216:219]
  v_mfma_f32_16x16x32_bf16 v[236:239], v[120:123], v[116:119], v[236:239]
  v_mfma_f32_16x16x32_bf16 v[180:183], v[124:127], v[104:107], v[180:183]
  v_mfma_f32_16x16x32_bf16 v[200:203], v[124:127], v[108:111], v[200:203]
  v_mfma_f32_16x16x32_bf16 v[220:223], v[124:127], v[112:115], v[220:223]
  v_mfma_f32_16x16x32_bf16 v[240:243], v[124:127], v[116:119], v[240:243]
  v_mfma_f32_16x16x32_bf16 v[184:187], v[128:131], v[104:107], v[184:187]
  v_mfma_f32_16x16x32_bf16 v[204:207], v[128:131], v[108:111], v[204:207]
  v_mfma_f32_16x16x32_bf16 v[224:227], v[128:131], v[112:115], v[224:227]
  v_mfma_f32_16x16x32_bf16 v[244:247], v[128:131], v[116:119], v[244:247]
  v_mfma_f32_16x16x32_bf16 v[188:191], v[132:135], v[104:107], v[188:191]
  v_mfma_f32_16x16x32_bf16 v[208:211], v[132:135], v[108:111], v[208:211]
  v_mfma_f32_16x16x32_bf16 v[228:231], v[132:135], v[112:115], v[228:231]
  v_mfma_f32_16x16x32_bf16 v[248:251], v[132:135], v[116:119], v[248:251]
  v_mfma_f32_16x16x32_bf16 v[192:195], v[136:139], v[104:107], v[192:195]
  v_mfma_f32_16x16x32_bf16 v[212:215], v[136:139], v[108:111], v[212:215]
  v_mfma_f32_16x16x32_bf16 v[232:235], v[136:139], v[112:115], v[232:235]
  v_mfma_f32_16x16x32_bf16 v[252:255], v[136:139], v[116:119], v[252:255]
  s_waitcnt vmcnt(0)
  v_cmp_ne_u32 vcc, 1, v28
  s_mov_b32 s14, 0
  s_nop 3
  s_cbranch_vccnz K2_NOY
  s_add_u32 s12, s10, 0
  buffer_load_dwordx2 v[32:33], v24, s[20:23], s12 offen sc1
  s_add_u32 s12, s10, 65536
  buffer_load_dwordx2 v[34:35], v24, s[20:23], s12 offen sc1
  s_add_u32 s12, s10, 131072
  buffer_load_dwordx2 v[36:37], v24, s[20:23], s12 offen sc1
  s_add_u32 s12, s10, 196608
  buffer_load_dwordx2 v[38:39], v24, s[20:23], s12 offen sc1
  s_add_u32 s12, s10, 262144
  buffer_load_dwordx2 v[40:41], v24, s[20:23], s12 offen sc1
  s_mov_b32 s14, 1
K2_NOY:
  v_mfma_f32_16x16x32_bf16 v[176:179], v[156:159], v[140:143], v[176:179]
  v_mfma_f32_16x16x32_bf16 v[196:199], v[156:159], v[144:147], v[196:199]
  v_mfma_f32_16x16x32_bf16 v[216:219], v[156:159], v[148:151], v[216:219]
  v_mfma_f32_16x16x32_bf16 v[236:239], v[156:159], v[152:155], v[236:239]
  v_mfma_f32_16x16x32_bf16 v[180:183], v[160:163], v[140:143], v[180:183]
  v_mfma_f32_16x16x32_bf16 v[200:203], v[160:163], v[144:147], v[200:203]
  v_mfma_f32_16x16x32_bf16 v[220:223], v[160:163], v[148:151], v[220:223]
  v_mfma_f32_16x16x32_bf16 v[240:243], v[160:163], v[152:155], v[240:243]
  v_mfma_f32_16x16x32_bf16 v[184:187], v[164:167], v[140:143], v[184:187]
  v_mfma_f32_16x16x32_bf16 v[204:207], v[164:167], v[144:147], v[204:207]
  v_mfma_f32_16x16x32_bf16 v[224:227], v[164:167], v[148:151], v[224:227]
  v_mfma_f32_16x16x32_bf16 v[244:247], v[164:167], v[152:155], v[244:247]
  v_mfma_f32_16x16x32_bf16 v[188:191], v[168:171], v[140:143], v[188:191]
  v_mfma_f32_16x16x32_bf16 v[208:211], v[168:171], v[144:147], v[208:211]
  v_mfma_f32_16x16x32_bf16 v[228:231], v[168:171], v[148:151], v[228:231]
  v_mfma_f32_16x16x32_bf16 v[248:251], v[168:171], v[152:155], v[248:251]
  v_mfma_f32_16x16x32_bf16 v[192:195], v[172:175], v[140:143], v[192:195]
  v_mfma_f32_16x16x32_bf16 v[212:215], v[172:175], v[144:147], v[212:215]
  v_mfma_f32_16x16x32_bf16 v[232:235], v[172:175], v[148:151], v[232:235]
  v_mfma_f32_16x16x32_bf16 v[252:255], v[172:175], v[152:155], v[252:255]
  v_lshlrev_b32 v26, 4, v1
  s_add_u32 s5, s52, 1
  s_and_b32 s5, s5, 3
  s_mul_i32 s5, s5, 15360
  s_add_u32 s5, s5, 87040
  v_add_u32 v27, s5, v26
  s_add_u32 s5, s52, 2
  s_and_b32 s5, s5, 3
  s_mul_i32 s5, s5, 15360
  s_add_u32 s5, s5, 92160
  v_add_u32 v28, s5, v26
  s_add_u32 s5, s52, 3
  s_and_b32 s5, s5, 3
  s_mul_i32 s5, s5, 15360
  s_add_u32 s5, s5, 97280
  v_add_u32 v29, s5, v26
  s_nop 7
  ds_write_b128 v27, v[196:199] offset:0
  ds_write_b128 v27, v[200:203] offset:1024
  ds_write_b128 v27, v[204:207] offset:2048
  ds_write_b128 v27, v[208:211] offset:3072
  ds_write_b128 v27, v[212:215] offset:4096
  ds_write_b128 v28, v[216:219] offset:0
  ds_write_b128 v28, v[220:223] offset:1024
  ds_write_b128 v28, v[224:227] offset:2048
  ds_write_b128 v28, v[228:231] offset:3072
  ds_write_b128 v28, v[232:235] offset:4096
  ds_write_b128 v29, v[236:239] offset:0
  ds_write_b128 v29, v[240:243] offset:1024
  ds_write_b128 v29, v[244:247] offset:2048
  ds_write_b128 v29, v[248:251] offset:3072
  ds_write_b128 v29, v[252:255] offset:4096
  s_mul_i32 s5, s52, 15360
  s_add_u32 s5, s5, 87040
  v_add_u32 v26, s5, v26
  s_or_b32 s15, s14, s52
  s_cmp_lg_u32 s15, 0
  s_cbranch_scc1 K2_POLLOK
  s_mov_b32 s13, 0
K2_POLL:
  s_add_u32 s13, s13, 1
  s_cmp_ge_u32 s13, 4194304
  s_cbranch_scc1 K2_POLLOK
  buffer_load_dword v28, v25, s[20:23], s11 offen sc1
  s_waitcnt vmcnt(0)
  v_cmp_ne_u32 vcc, 1, v28
  s_nop 3
  s_cbranch_vccnz K2_POLL
K2_POLLOK:
  s_waitcnt lgkmcnt(0)
  s_barrier
  s_cmp_lg_u32 s14, 0
  s_cbranch_scc1 K2_HAVEY
  s_add_u32 s12, s10, 0
  buffer_load_dwordx2 v[32:33], v24, s[20:23], s12 offen sc1
  s_add_u32 s12, s10, 65536
  buffer_load_dwordx2 v[34:35], v24, s[20:23], s12 offen sc1
  s_add_u32 s12, s10, 131072
  buffer_load_dwordx2 v[36:37], v24, s[20:23], s12 offen sc1
  s_add_u32 s12, s10, 196608
  buffer_load_dwordx2 v[38:39], v24, s[20:23], s12 offen sc1
  s_add_u32 s12, s10, 262144
  buffer_load_dwordx2 v[40:41], v24, s[20:23], s12 offen sc1
K2_HAVEY:
  ds_read_b128 v[68:71], v26 offset:0
  ds_read_b128 v[72:75], v26 offset:1024
  ds_read_b128 v[76:79], v26 offset:2048
  ds_read_b128 v[80:83], v26 offset:3072
  ds_read_b128 v[84:87], v26 offset:4096
  ds_read_b128 v[104:107], v26 offset:5120
  ds_read_b128 v[108:111], v26 offset:6144
  ds_read_b128 v[112:115], v26 offset:7168
  ds_read_b128 v[116:119], v26 offset:8192
  ds_read_b128 v[120:123], v26 offset:9216
  ds_read_b128 v[140:143], v26 offset:10240
  ds_read_b128 v[144:147], v26 offset:11264
  ds_read_b128 v[148:151], v26 offset:12288
  ds_read_b128 v[152:155], v26 offset:13312
  ds_read_b128 v[156:159], v26 offset:14336
  v_and_b32 v27, 15, v1
  v_lshrrev_b32 v28, 4, v1
  v_mul_u32_u24 v27, 160, v27
  v_lshl_add_u32 v27, v28, 3, v27
  v_add_u32 v27, s8, v27
  s_waitcnt lgkmcnt(10)
  v_pk_add_f32 v[176:177], v[176:177], v[68:69]
  v_pk_add_f32 v[178:179], v[178:179], v[70:71]
  v_pk_add_f32 v[180:181], v[180:181], v[72:73]
  v_pk_add_f32 v[182:183], v[182:183], v[74:75]
  v_pk_add_f32 v[184:185], v[184:185], v[76:77]
  v_pk_add_f32 v[186:187], v[186:187], v[78:79]
  v_pk_add_f32 v[188:189], v[188:189], v[80:81]
  v_pk_add_f32 v[190:191], v[190:191], v[82:83]
  v_pk_add_f32 v[192:193], v[192:193], v[84:85]
  v_pk_add_f32 v[194:195], v[194:195], v[86:87]
  s_waitcnt lgkmcnt(5)
  ds_read_b64 v[44:45], v27 offset:0
  ds_read_b64 v[46:47], v27 offset:32
  ds_read_b64 v[48:49], v27 offset:64
  ds_read_b64 v[50:51], v27 offset:96
  ds_read_b64 v[52:53], v27 offset:128
  s_waitcnt lgkmcnt(10)
  v_pk_add_f32 v[176:177], v[176:177], v[104:105]
  v_pk_add_f32 v[178:179], v[178:179], v[106:107]
  v_pk_add_f32 v[180:181], v[180:181], v[108:109]
  v_pk_add_f32 v[182:183], v[182:183], v[110:111]
  v_pk_add_f32 v[184:185], v[184:185], v[112:113]
  v_pk_add_f32 v[186:187], v[186:187], v[114:115]
  v_pk_add_f32 v[188:189], v[188:189], v[116:117]
  v_pk_add_f32 v[190:191], v[190:191], v[118:119]
  v_pk_add_f32 v[192:193], v[192:193], v[120:121]
  v_pk_add_f32 v[194:195], v[194:195], v[122:123]
  s_waitcnt lgkmcnt(5)
  v_pk_add_f32 v[176:177], v[176:177], v[140:141]
  v_pk_add_f32 v[178:179], v[178:179], v[142:143]
  v_pk_add_f32 v[180:181], v[180:181], v[144:145]
  v_pk_add_f32 v[182:183], v[182:183], v[146:147]
  v_pk_add_f32 v[184:185], v[184:185], v[148:149]
  v_pk_add_f32 v[186:187], v[186:187], v[150:151]
  v_pk_add_f32 v[188:189], v[188:189], v[152:153]
  v_pk_add_f32 v[190:191], v[190:191], v[154:155]
  v_pk_add_f32 v[192:193], v[192:193], v[156:157]
  v_pk_add_f32 v[194:195], v[194:195], v[158:159]
  s_mov_b32 s5, 0xffff0000
  s_waitcnt vmcnt(0) lgkmcnt(0)
  v_lshlrev_b32 v68, 16, v44
  v_and_b32 v69, s5, v44
  v_lshlrev_b32 v70, 16, v32
  v_and_b32 v71, s5, v32
  v_lshlrev_b32 v72, 16, v14
  v_and_b32 v73, s5, v14
  v_pk_add_f32 v[74:75], v[68:69], v[12:13] op_sel_hi:[1,0] neg_lo:[0,1] neg_hi:[0,1]
  v_pk_add_f32 v[176:177], v[176:177], v[72:73]
  v_pk_mul_f32 v[74:75], v[74:75], v[12:13] op_sel:[0,1] op_sel_hi:[1,1]
  v_pk_add_f32 v[176:177], v[176:177], v[68:69]
  v_pk_fma_f32 v[176:177], v[74:75], v[70:71], v[176:177]
  v_cvt_pk_bf16_f32 v44, v176, v177
  v_lshlrev_b32 v80, 16, v45
  v_and_b32 v81, s5, v45
  v_lshlrev_b32 v82, 16, v33
  v_and_b32 v83, s5, v33
  v_lshlrev_b32 v84, 16, v15
  v_and_b32 v85, s5, v15
  v_pk_add_f32 v[86:87], v[80:81], v[12:13] op_sel_hi:[1,0] neg_lo:[0,1] neg_hi:[0,1]
  v_pk_add_f32 v[178:179], v[178:179], v[84:85]
  v_pk_mul_f32 v[86:87], v[86:87], v[12:13] op_sel:[0,1] op_sel_hi:[1,1]
  v_pk_add_f32 v[178:179], v[178:179], v[80:81]
  v_pk_fma_f32 v[178:179], v[86:87], v[82:83], v[178:179]
  v_cvt_pk_bf16_f32 v45, v178, v179
  ds_write_b64 v27, v[44:45] offset:0
  v_lshlrev_b32 v68, 16, v46
  v_and_b32 v69, s5, v46
  v_lshlrev_b32 v70, 16, v34
  v_and_b32 v71, s5, v34
  v_lshlrev_b32 v72, 16, v16
  v_and_b32 v73, s5, v16
  v_pk_add_f32 v[74:75], v[68:69], v[12:13] op_sel_hi:[1,0] neg_lo:[0,1] neg_hi:[0,1]
  v_pk_add_f32 v[180:181], v[180:181], v[72:73]
  v_pk_mul_f32 v[74:75], v[74:75], v[12:13] op_sel:[0,1] op_sel_hi:[1,1]
  v_pk_add_f32 v[180:181], v[180:181], v[68:69]
  v_pk_fma_f32 v[180:181], v[74:75], v[70:71], v[180:181]
  v_cvt_pk_bf16_f32 v46, v180, v181
  v_lshlrev_b32 v80, 16, v47
  v_and_b32 v81, s5, v47
  v_lshlrev_b32 v82, 16, v35
  v_and_b32 v83, s5, v35
  v_lshlrev_b32 v84, 16, v17
  v_and_b32 v85, s5, v17
  v_pk_add_f32 v[86:87], v[80:81], v[12:13] op_sel_hi:[1,0] neg_lo:[0,1] neg_hi:[0,1]
  v_pk_add_f32 v[182:183], v[182:183], v[84:85]
  v_pk_mul_f32 v[86:87], v[86:87], v[12:13] op_sel:[0,1] op_sel_hi:[1,1]
  v_pk_add_f32 v[182:183], v[182:183], v[80:81]
  v_pk_fma_f32 v[182:183], v[86:87], v[82:83], v[182:183]
  v_cvt_pk_bf16_f32 v47, v182, v183
  ds_write_b64 v27, v[46:47] offset:32
  v_lshlrev_b32 v68, 16, v48
  v_and_b32 v69, s5, v48
  v_lshlrev_b32 v70, 16, v36
  v_and_b32 v71, s5, v36
  v_lshlrev_b32 v72, 16, v18
  v_and_b32 v73, s5, v18
  v_pk_add_f32 v[74:75], v[68:69], v[12:13] op_sel_hi:[1,0] neg_lo:[0,1] neg_hi:[0,1]
  v_pk_add_f32 v[184:185], v[184:185], v[72:73]
  v_pk_mul_f32 v[74:75], v[74:75], v[12:13] op_sel:[0,1] op_sel_hi:[1,1]
  v_pk_add_f32 v[184:185], v[184:185], v[68:69]
  v_pk_fma_f32 v[184:185], v[74:75], v[70:71], v[184:185]
  v_cvt_pk_bf16_f32 v48, v184, v185
  v_lshlrev_b32 v80, 16, v49
  v_and_b32 v81, s5, v49
  v_lshlrev_b32 v82, 16, v37
  v_and_b32 v83, s5, v37
  v_lshlrev_b32 v84, 16, v19
  v_and_b32 v85, s5, v19
  v_pk_add_f32 v[86:87], v[80:81], v[12:13] op_sel_hi:[1,0] neg_lo:[0,1] neg_hi:[0,1]
  v_pk_add_f32 v[186:187], v[186:187], v[84:85]
  v_pk_mul_f32 v[86:87], v[86:87], v[12:13] op_sel:[0,1] op_sel_hi:[1,1]
  v_pk_add_f32 v[186:187], v[186:187], v[80:81]
  v_pk_fma_f32 v[186:187], v[86:87], v[82:83], v[186:187]
  v_cvt_pk_bf16_f32 v49, v186, v187
  ds_write_b64 v27, v[48:49] offset:64
  v_lshlrev_b32 v68, 16, v50
  v_and_b32 v69, s5, v50
  v_lshlrev_b32 v70, 16, v38
  v_and_b32 v71, s5, v38
  v_lshlrev_b32 v72, 16, v20
  v_and_b32 v73, s5, v20
  v_pk_add_f32 v[74:75], v[68:69], v[12:13] op_sel_hi:[1,0] neg_lo:[0,1] neg_hi:[0,1]
  v_pk_add_f32 v[188:189], v[188:189], v[72:73]
  v_pk_mul_f32 v[74:75], v[74:75], v[12:13] op_sel:[0,1] op_sel_hi:[1,1]
  v_pk_add_f32 v[188:189], v[188:189], v[68:69]
  v_pk_fma_f32 v[188:189], v[74:75], v[70:71], v[188:189]
  v_cvt_pk_bf16_f32 v50, v188, v189
  v_lshlrev_b32 v80, 16, v51
  v_and_b32 v81, s5, v51
  v_lshlrev_b32 v82, 16, v39
  v_and_b32 v83, s5, v39
  v_lshlrev_b32 v84, 16, v21
  v_and_b32 v85, s5, v21
  v_pk_add_f32 v[86:87], v[80:81], v[12:13] op_sel_hi:[1,0] neg_lo:[0,1] neg_hi:[0,1]
  v_pk_add_f32 v[190:191], v[190:191], v[84:85]
  v_pk_mul_f32 v[86:87], v[86:87], v[12:13] op_sel:[0,1] op_sel_hi:[1,1]
  v_pk_add_f32 v[190:191], v[190:191], v[80:81]
  v_pk_fma_f32 v[190:191], v[86:87], v[82:83], v[190:191]
  v_cvt_pk_bf16_f32 v51, v190, v191
  ds_write_b64 v27, v[50:51] offset:96
  v_lshlrev_b32 v68, 16, v52
  v_and_b32 v69, s5, v52
  v_lshlrev_b32 v70, 16, v40
  v_and_b32 v71, s5, v40
  v_lshlrev_b32 v72, 16, v22
  v_and_b32 v73, s5, v22
  v_pk_add_f32 v[74:75], v[68:69], v[12:13] op_sel_hi:[1,0] neg_lo:[0,1] neg_hi:[0,1]
  v_pk_add_f32 v[192:193], v[192:193], v[72:73]
  v_pk_mul_f32 v[74:75], v[74:75], v[12:13] op_sel:[0,1] op_sel_hi:[1,1]
  v_pk_add_f32 v[192:193], v[192:193], v[68:69]
  v_pk_fma_f32 v[192:193], v[74:75], v[70:71], v[192:193]
  v_cvt_pk_bf16_f32 v52, v192, v193
  v_lshlrev_b32 v80, 16, v53
  v_and_b32 v81, s5, v53
  v_lshlrev_b32 v82, 16, v41
  v_and_b32 v83, s5, v41
  v_lshlrev_b32 v84, 16, v23
  v_and_b32 v85, s5, v23
  v_pk_add_f32 v[86:87], v[80:81], v[12:13] op_sel_hi:[1,0] neg_lo:[0,1] neg_hi:[0,1]
  v_pk_add_f32 v[194:195], v[194:195], v[84:85]
  v_pk_mul_f32 v[86:87], v[86:87], v[12:13] op_sel:[0,1] op_sel_hi:[1,1]
  v_pk_add_f32 v[194:195], v[194:195], v[80:81]
  v_pk_fma_f32 v[194:195], v[86:87], v[82:83], v[194:195]
  v_cvt_pk_bf16_f32 v53, v194, v195
  ds_write_b64 v27, v[52:53] offset:128
  v_lshlrev_b32 v26, 4, v1
  v_add_u32 v26, s8, v26
  s_waitcnt lgkmcnt(0)
  ds_read_b128 v[68:71], v26
  ds_read_b128 v[72:75], v26 offset:1024
  ds_read_b128 v[76:79], v26 offset:2048
  s_waitcnt lgkmcnt(2)
  buffer_store_dwordx4 v[68:71], v8, s[32:35], 0 offen
  s_waitcnt lgkmcnt(1)
  buffer_store_dwordx4 v[72:75], v9, s[32:35], 0 offen
  s_waitcnt lgkmcnt(0)
  buffer_store_dwordx4 v[76:79], v10, s[32:35], 0 offen
  s_endpgm
K2_CONV:
  s_cmp_ge_u32 s2, 160
  s_cbranch_scc1 K2_END
  s_load_dwordx2 s[4:5], s[0:1], 32
  s_load_dwordx2 s[6:7], s[0:1], 104
  s_load_dwordx2 s[28:29], s[0:1], 40
  s_load_dwordx2 s[32:33], s[0:1], 104
  s_setprio 3
  s_sub_u32 s53, s52, 4
  s_lshl_b32 s54, s2, 2
  s_add_u32 s54, s54, s53
  s_mul_i32 s55, s53, 21760
  s_mov_b32 s22, 4096
  s_mov_b32 s23, 0x00020000
  s_mov_b32 s26, 4096
  s_mov_b32 s27, 0x00020000
  s_mov_b32 s30, 1280
  s_mov_b32 s31, 0x00020000
  s_mov_b32 s34, 0xe50000
  s_mov_b32 s35, 0x00020000
  s_lshl_b32 s8, s54, 12
  s_add_u32 s9, s8, 8388608
  v_lshlrev_b32 v4, 4, v1
  v_add_u32 v5, -32, v4
  v_add_u32 v6, -16, v4
  s_lshl_b32 s10, s53, 2
  s_add_u32 s10, s10, 160768
  v_mov_b32 v7, s10
  v_mov_b32 v8, 0
  ds_write_b32 v7, v8
  v_mov_b32 v18, 160784
  ds_write_b32 v18, v8
  s_waitcnt lgkmcnt(0)
  s_barrier
  s_add_u32 s20, s4, s8
  s_addc_u32 s21, s5, 0
  s_add_u32 s24, s6, s9
  s_addc_u32 s25, s7, 0
  buffer_load_dwordx4 v[64:67], v5, s[20:23], 0 offen
  buffer_load_dwordx2 v[68:69], v6, s[20:23], 0 offen
  v_add_u32 v9, 992, v4
  v_add_u32 v10, 1008, v4
  buffer_load_dwordx4 v[72:75], v9, s[20:23], 0 offen
  buffer_load_dwordx2 v[76:77], v10, s[20:23], 0 offen
  v_add_u32 v9, 2016, v4
  v_add_u32 v10, 2032, v4
  buffer_load_dwordx4 v[80:83], v9, s[20:23], 0 offen
  buffer_load_dwordx2 v[84:85], v10, s[20:23], 0 offen
  v_add_u32 v9, 3040, v4
  v_add_u32 v10, 3056, v4
  buffer_load_dwordx4 v[88:91], v9, s[20:23], 0 offen
  buffer_load_dwordx2 v[92:93], v10, s[20:23], 0 offen
  v_add_u32 v9, 4064, v4
  v_add_u32 v10, 4080, v4
  buffer_load_dwordx4 v[96:99], v9, s[20:23], 0 offen
  buffer_load_dwordx2 v[100:101], v10, s[20:23], 0 offen
  s_add_u32 m0, s55, 0
  s_mov_b32 s11, 0
  buffer_load_dwordx4 v4, s[24:27], s11 offen lds
  s_add_u32 m0, s55, 1024
  s_mov_b32 s11, 1024
  buffer_load_dwordx4 v4, s[24:27], s11 offen lds
  s_add_u32 m0, s55, 2048
  s_mov_b32 s11, 2048
  buffer_load_dwordx4 v4, s[24:27], s11 offen lds
  s_add_u32 m0, s55, 3072
  s_mov_b32 s11, 3072
  buffer_load_dwordx4 v4, s[24:27], s11 offen lds
  s_add_u32 m0, s55, 4096
  s_mov_b32 s11, 4096
  buffer_load_dwordx4 v4, s[24:27], s11 offen lds
  s_lshl_b32 s11, s54, 1
  v_mov_b32 v9, s11
  buffer_load_ushort v11, v9, s[28:31], 0 offen
  v_add_u32 v12, s55, v4
  v_add_u32 v12, 5120, v12
  v_and_b32 v13, 15, v1
  v_lshrrev_b32 v14, 4, v1
  v_add_u32 v15, 1, v13
  v_and_b32 v16, 3, v15
  v_mul_u32_u24 v16, 4160, v16
  v_lshrrev_b32 v15, 2, v15
  v_lshl_add_u32 v16, v15, 3, v16
  v_lshl_add_u32 v16, v14, 4, v16
  s_add_u32 s11, s55, 5120
  v_add_u32 v2, s11, v16
  v_lshlrev_b32 v15, 5, v13
  v_lshlrev_b32 v16, 4, v14
  v_sub_u32 v16, v16, v15
  s_add_u32 s11, s55, 480
  v_add_u32 v3, s11, v16
  s_waitcnt vmcnt(14)
  v_alignbyte_b32 v112, v65, v64, 2
  v_alignbyte_b32 v113, v66, v65, 2
  v_alignbyte_b32 v114, v67, v66, 2
  v_alignbyte_b32 v115, v68, v67, 2
  v_alignbyte_b32 v116, v66, v65, 2
  v_alignbyte_b32 v117, v67, v66, 2
  v_alignbyte_b32 v118, v68, v67, 2
  v_alignbyte_b32 v119, v69, v68, 2
  ds_write_b128 v12, v[64:67] offset:0
  ds_write_b128 v12, v[112:115] offset:4160
  v_mov_b32 v120, v65
  v_mov_b32 v121, v66
  v_mov_b32 v122, v67
  v_mov_b32 v123, v68
  ds_write_b128 v12, v[116:119] offset:12480
  ds_write_b128 v12, v[120:123] offset:8320
  s_nop 1
  s_waitcnt vmcnt(12)
  v_alignbyte_b32 v112, v73, v72, 2
  v_alignbyte_b32 v113, v74, v73, 2
  v_alignbyte_b32 v114, v75, v74, 2
  v_alignbyte_b32 v115, v76, v75, 2
  v_alignbyte_b32 v116, v74, v73, 2
  v_alignbyte_b32 v117, v75, v74, 2
  v_alignbyte_b32 v118, v76, v75, 2
  v_alignbyte_b32 v119, v77, v76, 2
  ds_write_b128 v12, v[72:75] offset:1024
  ds_write_b128 v12, v[112:115] offset:5184
  v_mov_b32 v120, v73
  v_mov_b32 v121, v74
  v_mov_b32 v122, v75
  v_mov_b32 v123, v76
  ds_write_b128 v12, v[116:119] offset:13504
  ds_write_b128 v12, v[120:123] offset:9344
  s_nop 1
  s_waitcnt vmcnt(10)
  v_alignbyte_b32 v112, v81, v80, 2
  v_alignbyte_b32 v113, v82, v81, 2
  v_alignbyte_b32 v114, v83, v82, 2
  v_alignbyte_b32 v115, v84, v83, 2
  v_alignbyte_b32 v116, v82, v81, 2
  v_alignbyte_b32 v117, v83, v82, 2
  v_alignbyte_b32 v118, v84, v83, 2
  v_alignbyte_b32 v119, v85, v84, 2
  ds_write_b128 v12, v[80:83] offset:2048
  ds_write_b128 v12, v[112:115] offset:6208
  v_mov_b32 v120, v81
  v_mov_b32 v121, v82
  v_mov_b32 v122, v83
  v_mov_b32 v123, v84
  ds_write_b128 v12, v[116:119] offset:14528
  ds_write_b128 v12, v[120:123] offset:10368
  s_nop 1
  s_waitcnt vmcnt(8)
  v_alignbyte_b32 v112, v89, v88, 2
  v_alignbyte_b32 v113, v90, v89, 2
  v_alignbyte_b32 v114, v91, v90, 2
  v_alignbyte_b32 v115, v92, v91, 2
  v_alignbyte_b32 v116, v90, v89, 2
  v_alignbyte_b32 v117, v91, v90, 2
  v_alignbyte_b32 v118, v92, v91, 2
  v_alignbyte_b32 v119, v93, v92, 2
  ds_write_b128 v12, v[88:91] offset:3072
  ds_write_b128 v12, v[112:115] offset:7232
  v_mov_b32 v120, v89
  v_mov_b32 v121, v90
  v_mov_b32 v122, v91
  v_mov_b32 v123, v92
  ds_write_b128 v12, v[116:119] offset:15552
  ds_write_b128 v12, v[120:123] offset:11392
  s_nop 1
  s_waitcnt vmcnt(6)
  s_mov_b64 exec, 3
  v_alignbyte_b32 v112, v97, v96, 2
  v_alignbyte_b32 v113, v98, v97, 2
  v_alignbyte_b32 v114, v99, v98, 2
  v_alignbyte_b32 v115, v100, v99, 2
  v_alignbyte_b32 v116, v98, v97, 2
  v_alignbyte_b32 v117, v99, v98, 2
  v_alignbyte_b32 v118, v100, v99, 2
  v_alignbyte_b32 v119, v101, v100, 2
  ds_write_b128 v12, v[96:99] offset:4096
  ds_write_b128 v12, v[112:115] offset:8256
  v_mov_b32 v120, v97
  v_mov_b32 v121, v98
  v_mov_b32 v122, v99
  v_mov_b32 v123, v100
  ds_write_b128 v12, v[116:119] offset:16576
  ds_write_b128 v12, v[120:123] offset:12416
  s_mov_b64 exec, -1
  s_waitcnt vmcnt(0) lgkmcnt(0)
  ds_read_b128 v[128:131], v3 offset:3584
  ds_read_b128 v[132:135], v3 offset:3072
  ds_read_b128 v[136:139], v3 offset:2560
  ds_read_b128 v[140:143], v3 offset:2048
  ds_read_b128 v[144:147], v3 offset:1536
  ds_read_b128 v[148:151], v3 offset:1024
  ds_read_b128 v[152:155], v3 offset:512
  ds_read_b128 v[156:159], v3 offset:0
  ds_read_b64 v[64:65], v2 offset:0
  ds_read_b64 v[66:67], v2 offset:8
  ds_read_b64 v[68:69], v2 offset:512
  ds_read_b64 v[70:71], v2 offset:520
  s_waitcnt lgkmcnt(4)
  ds_read_b64 v[72:73], v2 offset:1024
  ds_read_b64 v[74:75], v2 offset:1032
  ds_read_b64 v[76:77], v2 offset:1536
  ds_read_b64 v[78:79], v2 offset:1544
  ds_read_b64 v[80:81], v2 offset:2048
  ds_read_b64 v[82:83], v2 offset:2056
  ds_read_b64 v[84:85], v2 offset:2560
  ds_read_b64 v[86:87], v2 offset:2568
  ds_read_b64 v[88:89], v2 offset:3072
  ds_read_b64 v[90:91], v2 offset:3080
  ds_read_b64 v[92:93], v2 offset:3584
  ds_read_b64 v[94:95], v2 offset:3592
  s_waitcnt lgkmcnt(0)
  v_mfma_f32_16x16x32_bf16 v[220:223], v[64:67], v[156:159], 0
  ds_read_b128 v[160:163], v3 offset:3648
  v_mfma_f32_16x16x32_bf16 v[216:219], v[64:67], v[152:155], 0
  ds_read_b128 v[164:167], v3 offset:3136
  v_mfma_f32_16x16x32_bf16 v[212:215], v[64:67], v[148:151], 0
  ds_read_b128 v[168:171], v3 offset:2624
  v_mfma_f32_16x16x32_bf16 v[220:223], v[68:71], v[152:155], v[220:223]
  ds_read_b128 v[172:175], v3 offset:2112
  v_mfma_f32_16x16x32_bf16 v[216:219], v[68:71], v[148:151], v[216:219]
  ds_read_b128 v[176:179], v3 offset:1600
  v_mfma_f32_16x16x32_bf16 v[208:211], v[64:67], v[144:147], 0
  ds_read_b128 v[180:183], v3 offset:1088
  v_mfma_f32_16x16x32_bf16 v[220:223], v[72:75], v[148:151], v[220:223]
  ds_read_b128 v[184:187], v3 offset:576
  v_mfma_f32_16x16x32_bf16 v[212:215], v[68:71], v[144:147], v[212:215]
  ds_read_b128 v[188:191], v3 offset:64
  v_mfma_f32_16x16x32_bf16 v[216:219], v[72:75], v[144:147], v[216:219]
  ds_read_b64 v[96:97], v2 offset:64
  v_mfma_f32_16x16x32_bf16 v[220:223], v[76:79], v[144:147], v[220:223]
  ds_read_b64 v[98:99], v2 offset:72
  v_mfma_f32_16x16x32_bf16 v[204:207], v[64:67], v[140:143], 0
  ds_read_b64 v[100:101], v2 offset:576
  v_mfma_f32_16x16x32_bf16 v[208:211], v[68:71], v[140:143], v[208:211]
  ds_read_b64 v[102:103], v2 offset:584
  v_mfma_f32_16x16x32_bf16 v[212:215], v[72:75], v[140:143], v[212:215]
  ds_read_b64 v[104:105], v2 offset:1088
  v_mfma_f32_16x16x32_bf16 v[216:219], v[76:79], v[140:143], v[216:219]
  ds_read_b64 v[106:107], v2 offset:1096
  v_mfma_f32_16x16x32_bf16 v[220:223], v[80:83], v[140:143], v[220:223]
  ds_read_b64 v[108:109], v2 offset:1600
  v_mfma_f32_16x16x32_bf16 v[200:203], v[64:67], v[136:139], 0
  ds_read_b64 v[110:111], v2 offset:1608
  v_mfma_f32_16x16x32_bf16 v[204:207], v[68:71], v[136:139], v[204:207]
  ds_read_b64 v[112:113], v2 offset:2112
  v_mfma_f32_16x16x32_bf16 v[208:211], v[72:75], v[136:139], v[208:211]
  ds_read_b64 v[114:115], v2 offset:2120
  v_mfma_f32_16x16x32_bf16 v[212:215], v[76:79], v[136:139], v[212:215]
  ds_read_b64 v[116:117], v2 offset:2624
  v_mfma_f32_16x16x32_bf16 v[216:219], v[80:83], v[136:139], v[216:219]
  ds_read_b64 v[118:119], v2 offset:2632
  v_mfma_f32_16x16x32_bf16 v[220:223], v[84:87], v[136:139], v[220:223]
  ds_read_b64 v[120:121], v2 offset:3136
  v_mfma_f32_16x16x32_bf16 v[196:199], v[64:67], v[132:135], 0
  ds_read_b64 v[122:123], v2 offset:3144
  v_mfma_f32_16x16x32_bf16 v[200:203], v[68:71], v[132:135], v[200:203]
  ds_read_b64 v[124:125], v2 offset:3648
  v_mfma_f32_16x16x32_bf16 v[204:207], v[72:75], v[132:135], v[204:207]
  ds_read_b64 v[126:127], v2 offset:3656
  v_mfma_f32_16x16x32_bf16 v[208:211], v[76:79], v[132:135], v[208:211]
  v_mfma_f32_16x16x32_bf16 v[212:215], v[80:83], v[132:135], v[212:215]
  v_mfma_f32_16x16x32_bf16 v[216:219], v[84:87], v[132:135], v[216:219]
  v_mfma_f32_16x16x32_bf16 v[220:223], v[88:91], v[132:135], v[220:223]
  v_mfma_f32_16x16x32_bf16 v[192:195], v[64:67], v[128:131], 0
  v_mfma_f32_16x16x32_bf16 v[196:199], v[68:71], v[128:131], v[196:199]
  v_mfma_f32_16x16x32_bf16 v[200:203], v[72:75], v[128:131], v[200:203]
  v_mfma_f32_16x16x32_bf16 v[204:207], v[76:79], v[128:131], v[204:207]
  v_mfma_f32_16x16x32_bf16 v[208:211], v[80:83], v[128:131], v[208:211]
  v_mfma_f32_16x16x32_bf16 v[212:215], v[84:87], v[128:131], v[212:215]
  v_mfma_f32_16x16x32_bf16 v[216:219], v[88:91], v[128:131], v[216:219]
  v_mfma_f32_16x16x32_bf16 v[220:223], v[92:95], v[128:131], v[220:223]
  s_waitcnt lgkmcnt(0)
  v_mfma_f32_16x16x32_bf16 v[220:223], v[96:99], v[188:191], v[220:223]
  ds_read_b128 v[128:131], v3 offset:3712
  v_mfma_f32_16x16x32_bf16 v[216:219], v[96:99], v[184:187], v[216:219]
  ds_read_b128 v[132:135], v3 offset:3200
  v_mfma_f32_16x16x32_bf16 v[212:215], v[96:99], v[180:183], v[212:215]
  ds_read_b128 v[136:139], v3 offset:2688
  v_mfma_f32_16x16x32_bf16 v[220:223], v[100:103], v[184:187], v[220:223]
  ds_read_b128 v[140:143], v3 offset:2176
  v_mfma_f32_16x16x32_bf16 v[216:219], v[100:103], v[180:183], v[216:219]
  ds_read_b128 v[144:147], v3 offset:1664
  v_mfma_f32_16x16x32_bf16 v[208:211], v[96:99], v[176:179], v[208:211]
  ds_read_b128 v[148:151], v3 offset:1152
  v_mfma_f32_16x16x32_bf16 v[220:223], v[104:107], v[180:183], v[220:223]
  ds_read_b128 v[152:155], v3 offset:640
  v_mfma_f32_16x16x32_bf16 v[212:215], v[100:103], v[176:179], v[212:215]
  ds_read_b128 v[156:159], v3 offset:128
  v_mfma_f32_16x16x32_bf16 v[216:219], v[104:107], v[176:179], v[216:219]
  ds_read_b64 v[64:65], v2 offset:128
  v_mfma_f32_16x16x32_bf16 v[220:223], v[108:111], v[176:179], v[220:223]
  ds_read_b64 v[66:67], v2 offset:136
  v_mfma_f32_16x16x32_bf16 v[204:207], v[96:99], v[172:175], v[204:207]
  ds_read_b64 v[68:69], v2 offset:640
  v_mfma_f32_16x16x32_bf16 v[208:211], v[100:103], v[172:175], v[208:211]
  ds_read_b64 v[70:71], v2 offset:648
  v_mfma_f32_16x16x32_bf16 v[212:215], v[104:107], v[172:175], v[212:215]
  ds_read_b64 v[72:73], v2 offset:1152
  v_mfma_f32_16x16x32_bf16 v[216:219], v[108:111], v[172:175], v[216:219]
  ds_read_b64 v[74:75], v2 offset:1160
  v_mfma_f32_16x16x32_bf16 v[220:223], v[112:115], v[172:175], v[220:223]
  ds_read_b64 v[76:77], v2 offset:1664
  v_mfma_f32_16x16x32_bf16 v[200:203], v[96:99], v[168:171], v[200:203]
  ds_read_b64 v[78:79], v2 offset:1672
  v_mfma_f32_16x16x32_bf16 v[204:207], v[100:103], v[168:171], v[204:207]
  ds_read_b64 v[80:81], v2 offset:2176
  v_mfma_f32_16x16x32_bf16 v[208:211], v[104:107], v[168:171], v[208:211]
  ds_read_b64 v[82:83], v2 offset:2184
  v_mfma_f32_16x16x32_bf16 v[212:215], v[108:111], v[168:171], v[212:215]
  ds_read_b64 v[84:85], v2 offset:2688
  v_mfma_f32_16x16x32_bf16 v[216:219], v[112:115], v[168:171], v[216:219]
  ds_read_b64 v[86:87], v2 offset:2696
  v_mfma_f32_16x16x32_bf16 v[220:223], v[116:119], v[168:171], v[220:223]
  ds_read_b64 v[88:89], v2 offset:3200
  v_mfma_f32_16x16x32_bf16 v[196:199], v[96:99], v[164:167], v[196:199]
  ds_read_b64 v[90:91], v2 offset:3208
  v_mfma_f32_16x16x32_bf16 v[200:203], v[100:103], v[164:167], v[200:203]
  ds_read_b64 v[92:93], v2 offset:3712
  v_mfma_f32_16x16x32_bf16 v[204:207], v[104:107], v[164:167], v[204:207]
  ds_read_b64 v[94:95], v2 offset:3720
  v_mfma_f32_16x16x32_bf16 v[208:211], v[108:111], v[164:167], v[208:211]
  v_mfma_f32_16x16x32_bf16 v[212:215], v[112:115], v[164:167], v[212:215]
  v_mfma_f32_16x16x32_bf16 v[216:219], v[116:119], v[164:167], v[216:219]
  v_mfma_f32_16x16x32_bf16 v[220:223], v[120:123], v[164:167], v[220:223]
  v_mfma_f32_16x16x32_bf16 v[192:195], v[96:99], v[160:163], v[192:195]
  v_mfma_f32_16x16x32_bf16 v[196:199], v[100:103], v[160:163], v[196:199]
  v_mfma_f32_16x16x32_bf16 v[200:203], v[104:107], v[160:163], v[200:203]
  v_mfma_f32_16x16x32_bf16 v[204:207], v[108:111], v[160:163], v[204:207]
  v_mfma_f32_16x16x32_bf16 v[208:211], v[112:115], v[160:163], v[208:211]
  v_mfma_f32_16x16x32_bf16 v[212:215], v[116:119], v[160:163], v[212:215]
  v_mfma_f32_16x16x32_bf16 v[216:219], v[120:123], v[160:163], v[216:219]
  v_mfma_f32_16x16x32_bf16 v[220:223], v[124:127], v[160:163], v[220:223]
  s_waitcnt lgkmcnt(0)
  v_mfma_f32_16x16x32_bf16 v[220:223], v[64:67], v[156:159], v[220:223]
  ds_read_b128 v[160:163], v3 offset:3776
  v_mfma_f32_16x16x32_bf16 v[216:219], v[64:67], v[152:155], v[216:219]
  ds_read_b128 v[164:167], v3 offset:3264
  v_mfma_f32_16x16x32_bf16 v[212:215], v[64:67], v[148:151], v[212:215]
  ds_read_b128 v[168:171], v3 offset:2752
  v_mfma_f32_16x16x32_bf16 v[220:223], v[68:71], v[152:155], v[220:223]
  ds_read_b128 v[172:175], v3 offset:2240
  v_mfma_f32_16x16x32_bf16 v[216:219], v[68:71], v[148:151], v[216:219]
  ds_read_b128 v[176:179], v3 offset:1728
  v_mfma_f32_16x16x32_bf16 v[208:211], v[64:67], v[144:147], v[208:211]
  ds_read_b128 v[180:183], v3 offset:1216
  v_mfma_f32_16x16x32_bf16 v[220:223], v[72:75], v[148:151], v[220:223]
  ds_read_b128 v[184:187], v3 offset:704
  v_mfma_f32_16x16x32_bf16 v[212:215], v[68:71], v[144:147], v[212:215]
  ds_read_b128 v[188:191], v3 offset:192
  v_mfma_f32_16x16x32_bf16 v[216:219], v[72:75], v[144:147], v[216:219]
  ds_read_b64 v[96:97], v2 offset:192
  v_mfma_f32_16x16x32_bf16 v[220:223], v[76:79], v[144:147], v[220:223]
  ds_read_b64 v[98:99], v2 offset:200
  v_mfma_f32_16x16x32_bf16 v[204:207], v[64:67], v[140:143], v[204:207]
  ds_read_b64 v[100:101], v2 offset:704
  v_mfma_f32_16x16x32_bf16 v[208:211], v[68:71], v[140:143], v[208:211]
  ds_read_b64 v[102:103], v2 offset:712
  v_mfma_f32_16x16x32_bf16 v[212:215], v[72:75], v[140:143], v[212:215]
  ds_read_b64 v[104:105], v2 offset:1216
  v_mfma_f32_16x16x32_bf16 v[216:219], v[76:79], v[140:143], v[216:219]
  ds_read_b64 v[106:107], v2 offset:1224
  v_mfma_f32_16x16x32_bf16 v[220:223], v[80:83], v[140:143], v[220:223]
  ds_read_b64 v[108:109], v2 offset:1728
  v_mfma_f32_16x16x32_bf16 v[200:203], v[64:67], v[136:139], v[200:203]
  ds_read_b64 v[110:111], v2 offset:1736
  v_mfma_f32_16x16x32_bf16 v[204:207], v[68:71], v[136:139], v[204:207]
  ds_read_b64 v[112:113], v2 offset:2240
  v_mfma_f32_16x16x32_bf16 v[208:211], v[72:75], v[136:139], v[208:211]
  ds_read_b64 v[114:115], v2 offset:2248
  v_mfma_f32_16x16x32_bf16 v[212:215], v[76:79], v[136:139], v[212:215]
  ds_read_b64 v[116:117], v2 offset:2752
  v_mfma_f32_16x16x32_bf16 v[216:219], v[80:83], v[136:139], v[216:219]
  ds_read_b64 v[118:119], v2 offset:2760
  v_mfma_f32_16x16x32_bf16 v[220:223], v[84:87], v[136:139], v[220:223]
  ds_read_b64 v[120:121], v2 offset:3264
  v_mfma_f32_16x16x32_bf16 v[196:199], v[64:67], v[132:135], v[196:199]
  ds_read_b64 v[122:123], v2 offset:3272
  v_mfma_f32_16x16x32_bf16 v[200:203], v[68:71], v[132:135], v[200:203]
  ds_read_b64 v[124:125], v2 offset:3776
  v_mfma_f32_16x16x32_bf16 v[204:207], v[72:75], v[132:135], v[204:207]
  ds_read_b64 v[126:127], v2 offset:3784
  v_mfma_f32_16x16x32_bf16 v[208:211], v[76:79], v[132:135], v[208:211]
  v_mfma_f32_16x16x32_bf16 v[212:215], v[80:83], v[132:135], v[212:215]
  v_mfma_f32_16x16x32_bf16 v[216:219], v[84:87], v[132:135], v[216:219]
  v_mfma_f32_16x16x32_bf16 v[220:223], v[88:91], v[132:135], v[220:223]
  v_mfma_f32_16x16x32_bf16 v[192:195], v[64:67], v[128:131], v[192:195]
  v_mfma_f32_16x16x32_bf16 v[196:199], v[68:71], v[128:131], v[196:199]
  v_mfma_f32_16x16x32_bf16 v[200:203], v[72:75], v[128:131], v[200:203]
  v_mfma_f32_16x16x32_bf16 v[204:207], v[76:79], v[128:131], v[204:207]
  v_mfma_f32_16x16x32_bf16 v[208:211], v[80:83], v[128:131], v[208:211]
  v_mfma_f32_16x16x32_bf16 v[212:215], v[84:87], v[128:131], v[212:215]
  v_mfma_f32_16x16x32_bf16 v[216:219], v[88:91], v[128:131], v[216:219]
  v_mfma_f32_16x16x32_bf16 v[220:223], v[92:95], v[128:131], v[220:223]
  s_waitcnt lgkmcnt(0)
  v_mfma_f32_16x16x32_bf16 v[220:223], v[96:99], v[188:191], v[220:223]
  ds_read_b128 v[128:131], v3 offset:3840
  v_mfma_f32_16x16x32_bf16 v[216:219], v[96:99], v[184:187], v[216:219]
  ds_read_b128 v[132:135], v3 offset:3328
  v_mfma_f32_16x16x32_bf16 v[212:215], v[96:99], v[180:183], v[212:215]
  ds_read_b128 v[136:139], v3 offset:2816
  v_mfma_f32_16x16x32_bf16 v[220:223], v[100:103], v[184:187], v[220:223]
  ds_read_b128 v[140:143], v3 offset:2304
  v_mfma_f32_16x16x32_bf16 v[216:219], v[100:103], v[180:183], v[216:219]
  ds_read_b128 v[144:147], v3 offset:1792
  v_mfma_f32_16x16x32_bf16 v[208:211], v[96:99], v[176:179], v[208:211]
  ds_read_b128 v[148:151], v3 offset:1280
  v_mfma_f32_16x16x32_bf16 v[220:223], v[104:107], v[180:183], v[220:223]
  ds_read_b128 v[152:155], v3 offset:768
  v_mfma_f32_16x16x32_bf16 v[212:215], v[100:103], v[176:179], v[212:215]
  ds_read_b128 v[156:159], v3 offset:256
  v_mfma_f32_16x16x32_bf16 v[216:219], v[104:107], v[176:179], v[216:219]
  ds_read_b64 v[64:65], v2 offset:256
  v_mfma_f32_16x16x32_bf16 v[220:223], v[108:111], v[176:179], v[220:223]
  ds_read_b64 v[66:67], v2 offset:264
  v_mfma_f32_16x16x32_bf16 v[204:207], v[96:99], v[172:175], v[204:207]
  ds_read_b64 v[68:69], v2 offset:768
  v_mfma_f32_16x16x32_bf16 v[208:211], v[100:103], v[172:175], v[208:211]
  ds_read_b64 v[70:71], v2 offset:776
  v_mfma_f32_16x16x32_bf16 v[212:215], v[104:107], v[172:175], v[212:215]
  ds_read_b64 v[72:73], v2 offset:1280
  v_mfma_f32_16x16x32_bf16 v[216:219], v[108:111], v[172:175], v[216:219]
  ds_read_b64 v[74:75], v2 offset:1288
  v_mfma_f32_16x16x32_bf16 v[220:223], v[112:115], v[172:175], v[220:223]
  ds_read_b64 v[76:77], v2 offset:1792
  v_mfma_f32_16x16x32_bf16 v[200:203], v[96:99], v[168:171], v[200:203]
  ds_read_b64 v[78:79], v2 offset:1800
  v_mfma_f32_16x16x32_bf16 v[204:207], v[100:103], v[168:171], v[204:207]
  ds_read_b64 v[80:81], v2 offset:2304
  v_mfma_f32_16x16x32_bf16 v[208:211], v[104:107], v[168:171], v[208:211]
  ds_read_b64 v[82:83], v2 offset:2312
  v_mfma_f32_16x16x32_bf16 v[212:215], v[108:111], v[168:171], v[212:215]
  ds_read_b64 v[84:85], v2 offset:2816
  v_mfma_f32_16x16x32_bf16 v[216:219], v[112:115], v[168:171], v[216:219]
  ds_read_b64 v[86:87], v2 offset:2824
  v_mfma_f32_16x16x32_bf16 v[220:223], v[116:119], v[168:171], v[220:223]
  ds_read_b64 v[88:89], v2 offset:3328
  v_mfma_f32_16x16x32_bf16 v[196:199], v[96:99], v[164:167], v[196:199]
  ds_read_b64 v[90:91], v2 offset:3336
  v_mfma_f32_16x16x32_bf16 v[200:203], v[100:103], v[164:167], v[200:203]
  ds_read_b64 v[92:93], v2 offset:3840
  v_mfma_f32_16x16x32_bf16 v[204:207], v[104:107], v[164:167], v[204:207]
  ds_read_b64 v[94:95], v2 offset:3848
  v_mfma_f32_16x16x32_bf16 v[208:211], v[108:111], v[164:167], v[208:211]
  v_mfma_f32_16x16x32_bf16 v[212:215], v[112:115], v[164:167], v[212:215]
  v_mfma_f32_16x16x32_bf16 v[216:219], v[116:119], v[164:167], v[216:219]
  v_mfma_f32_16x16x32_bf16 v[220:223], v[120:123], v[164:167], v[220:223]
  v_mfma_f32_16x16x32_bf16 v[192:195], v[96:99], v[160:163], v[192:195]
  v_mfma_f32_16x16x32_bf16 v[196:199], v[100:103], v[160:163], v[196:199]
  v_mfma_f32_16x16x32_bf16 v[200:203], v[104:107], v[160:163], v[200:203]
  v_mfma_f32_16x16x32_bf16 v[204:207], v[108:111], v[160:163], v[204:207]
  v_mfma_f32_16x16x32_bf16 v[208:211], v[112:115], v[160:163], v[208:211]
  v_mfma_f32_16x16x32_bf16 v[212:215], v[116:119], v[160:163], v[212:215]
  v_mfma_f32_16x16x32_bf16 v[216:219], v[120:123], v[160:163], v[216:219]
  v_mfma_f32_16x16x32_bf16 v[220:223], v[124:127], v[160:163], v[220:223]
  s_waitcnt lgkmcnt(0)
  v_mfma_f32_16x16x32_bf16 v[220:223], v[64:67], v[156:159], v[220:223]
  ds_read_b128 v[160:163], v3 offset:3904
  v_mfma_f32_16x16x32_bf16 v[216:219], v[64:67], v[152:155], v[216:219]
  ds_read_b128 v[164:167], v3 offset:3392
  v_mfma_f32_16x16x32_bf16 v[212:215], v[64:67], v[148:151], v[212:215]
  ds_read_b128 v[168:171], v3 offset:2880
  v_mfma_f32_16x16x32_bf16 v[220:223], v[68:71], v[152:155], v[220:223]
  ds_read_b128 v[172:175], v3 offset:2368
  v_mfma_f32_16x16x32_bf16 v[216:219], v[68:71], v[148:151], v[216:219]
  ds_read_b128 v[176:179], v3 offset:1856
  v_mfma_f32_16x16x32_bf16 v[208:211], v[64:67], v[144:147], v[208:211]
  ds_read_b128 v[180:183], v3 offset:1344
  v_mfma_f32_16x16x32_bf16 v[220:223], v[72:75], v[148:151], v[220:223]
  ds_read_b128 v[184:187], v3 offset:832
  v_mfma_f32_16x16x32_bf16 v[212:215], v[68:71], v[144:147], v[212:215]
  ds_read_b128 v[188:191], v3 offset:320
  v_mfma_f32_16x16x32_bf16 v[216:219], v[72:75], v[144:147], v[216:219]
  ds_read_b64 v[96:97], v2 offset:320
  v_mfma_f32_16x16x32_bf16 v[220:223], v[76:79], v[144:147], v[220:223]
  ds_read_b64 v[98:99], v2 offset:328
  v_mfma_f32_16x16x32_bf16 v[204:207], v[64:67], v[140:143], v[204:207]
  ds_read_b64 v[100:101], v2 offset:832
  v_mfma_f32_16x16x32_bf16 v[208:211], v[68:71], v[140:143], v[208:211]
  ds_read_b64 v[102:103], v2 offset:840
  v_mfma_f32_16x16x32_bf16 v[212:215], v[72:75], v[140:143], v[212:215]
  ds_read_b64 v[104:105], v2 offset:1344
  v_mfma_f32_16x16x32_bf16 v[216:219], v[76:79], v[140:143], v[216:219]
  ds_read_b64 v[106:107], v2 offset:1352
  v_mfma_f32_16x16x32_bf16 v[220:223], v[80:83], v[140:143], v[220:223]
  ds_read_b64 v[108:109], v2 offset:1856
  v_mfma_f32_16x16x32_bf16 v[200:203], v[64:67], v[136:139], v[200:203]
  ds_read_b64 v[110:111], v2 offset:1864
  v_mfma_f32_16x16x32_bf16 v[204:207], v[68:71], v[136:139], v[204:207]
  ds_read_b64 v[112:113], v2 offset:2368
  v_mfma_f32_16x16x32_bf16 v[208:211], v[72:75], v[136:139], v[208:211]
  ds_read_b64 v[114:115], v2 offset:2376
  v_mfma_f32_16x16x32_bf16 v[212:215], v[76:79], v[136:139], v[212:215]
  ds_read_b64 v[116:117], v2 offset:2880
  v_mfma_f32_16x16x32_bf16 v[216:219], v[80:83], v[136:139], v[216:219]
  ds_read_b64 v[118:119], v2 offset:2888
  v_mfma_f32_16x16x32_bf16 v[220:223], v[84:87], v[136:139], v[220:223]
  ds_read_b64 v[120:121], v2 offset:3392
  v_mfma_f32_16x16x32_bf16 v[196:199], v[64:67], v[132:135], v[196:199]
  ds_read_b64 v[122:123], v2 offset:3400
  v_mfma_f32_16x16x32_bf16 v[200:203], v[68:71], v[132:135], v[200:203]
  ds_read_b64 v[124:125], v2 offset:3904
  v_mfma_f32_16x16x32_bf16 v[204:207], v[72:75], v[132:135], v[204:207]
  ds_read_b64 v[126:127], v2 offset:3912
  v_mfma_f32_16x16x32_bf16 v[208:211], v[76:79], v[132:135], v[208:211]
  v_mfma_f32_16x16x32_bf16 v[212:215], v[80:83], v[132:135], v[212:215]
  v_mfma_f32_16x16x32_bf16 v[216:219], v[84:87], v[132:135], v[216:219]
  v_mfma_f32_16x16x32_bf16 v[220:223], v[88:91], v[132:135], v[220:223]
  v_mfma_f32_16x16x32_bf16 v[192:195], v[64:67], v[128:131], v[192:195]
  v_mfma_f32_16x16x32_bf16 v[196:199], v[68:71], v[128:131], v[196:199]
  v_mfma_f32_16x16x32_bf16 v[200:203], v[72:75], v[128:131], v[200:203]
  v_mfma_f32_16x16x32_bf16 v[204:207], v[76:79], v[128:131], v[204:207]
  v_mfma_f32_16x16x32_bf16 v[208:211], v[80:83], v[128:131], v[208:211]
  v_mfma_f32_16x16x32_bf16 v[212:215], v[84:87], v[128:131], v[212:215]
  v_mfma_f32_16x16x32_bf16 v[216:219], v[88:91], v[128:131], v[216:219]
  v_mfma_f32_16x16x32_bf16 v[220:223], v[92:95], v[128:131], v[220:223]
  s_waitcnt lgkmcnt(0)
  v_mfma_f32_16x16x32_bf16 v[220:223], v[96:99], v[188:191], v[220:223]
  ds_read_b128 v[128:131], v3 offset:3968
  v_mfma_f32_16x16x32_bf16 v[216:219], v[96:99], v[184:187], v[216:219]
  ds_read_b128 v[132:135], v3 offset:3456
  v_mfma_f32_16x16x32_bf16 v[212:215], v[96:99], v[180:183], v[212:215]
  ds_read_b128 v[136:139], v3 offset:2944
  v_mfma_f32_16x16x32_bf16 v[220:223], v[100:103], v[184:187], v[220:223]
  ds_read_b128 v[140:143], v3 offset:2432
  v_mfma_f32_16x16x32_bf16 v[216:219], v[100:103], v[180:183], v[216:219]
  ds_read_b128 v[144:147], v3 offset:1920
  v_mfma_f32_16x16x32_bf16 v[208:211], v[96:99], v[176:179], v[208:211]
  ds_read_b128 v[148:151], v3 offset:1408
  v_mfma_f32_16x16x32_bf16 v[220:223], v[104:107], v[180:183], v[220:223]
  ds_read_b128 v[152:155], v3 offset:896
  v_mfma_f32_16x16x32_bf16 v[212:215], v[100:103], v[176:179], v[212:215]
  ds_read_b128 v[156:159], v3 offset:384
  v_mfma_f32_16x16x32_bf16 v[216:219], v[104:107], v[176:179], v[216:219]
  ds_read_b64 v[64:65], v2 offset:384
  v_mfma_f32_16x16x32_bf16 v[220:223], v[108:111], v[176:179], v[220:223]
  ds_read_b64 v[66:67], v2 offset:392
  v_mfma_f32_16x16x32_bf16 v[204:207], v[96:99], v[172:175], v[204:207]
  ds_read_b64 v[68:69], v2 offset:896
  v_mfma_f32_16x16x32_bf16 v[208:211], v[100:103], v[172:175], v[208:211]
  ds_read_b64 v[70:71], v2 offset:904
  v_mfma_f32_16x16x32_bf16 v[212:215], v[104:107], v[172:175], v[212:215]
  ds_read_b64 v[72:73], v2 offset:1408
  v_mfma_f32_16x16x32_bf16 v[216:219], v[108:111], v[172:175], v[216:219]
  ds_read_b64 v[74:75], v2 offset:1416
  v_mfma_f32_16x16x32_bf16 v[220:223], v[112:115], v[172:175], v[220:223]
  ds_read_b64 v[76:77], v2 offset:1920
  v_mfma_f32_16x16x32_bf16 v[200:203], v[96:99], v[168:171], v[200:203]
  ds_read_b64 v[78:79], v2 offset:1928
  v_mfma_f32_16x16x32_bf16 v[204:207], v[100:103], v[168:171], v[204:207]
  ds_read_b64 v[80:81], v2 offset:2432
  v_mfma_f32_16x16x32_bf16 v[208:211], v[104:107], v[168:171], v[208:211]
  ds_read_b64 v[82:83], v2 offset:2440
  v_mfma_f32_16x16x32_bf16 v[212:215], v[108:111], v[168:171], v[212:215]
  ds_read_b64 v[84:85], v2 offset:2944
  v_mfma_f32_16x16x32_bf16 v[216:219], v[112:115], v[168:171], v[216:219]
  ds_read_b64 v[86:87], v2 offset:2952
  v_mfma_f32_16x16x32_bf16 v[220:223], v[116:119], v[168:171], v[220:223]
  ds_read_b64 v[88:89], v2 offset:3456
  v_mfma_f32_16x16x32_bf16 v[196:199], v[96:99], v[164:167], v[196:199]
  ds_read_b64 v[90:91], v2 offset:3464
  v_mfma_f32_16x16x32_bf16 v[200:203], v[100:103], v[164:167], v[200:203]
  ds_read_b64 v[92:93], v2 offset:3968
  v_mfma_f32_16x16x32_bf16 v[204:207], v[104:107], v[164:167], v[204:207]
  ds_read_b64 v[94:95], v2 offset:3976
  v_mfma_f32_16x16x32_bf16 v[208:211], v[108:111], v[164:167], v[208:211]
  v_mfma_f32_16x16x32_bf16 v[212:215], v[112:115], v[164:167], v[212:215]
  v_mfma_f32_16x16x32_bf16 v[216:219], v[116:119], v[164:167], v[216:219]
  v_mfma_f32_16x16x32_bf16 v[220:223], v[120:123], v[164:167], v[220:223]
  v_mfma_f32_16x16x32_bf16 v[192:195], v[96:99], v[160:163], v[192:195]
  v_mfma_f32_16x16x32_bf16 v[196:199], v[100:103], v[160:163], v[196:199]
  v_mfma_f32_16x16x32_bf16 v[200:203], v[104:107], v[160:163], v[200:203]
  v_mfma_f32_16x16x32_bf16 v[204:207], v[108:111], v[160:163], v[204:207]
  v_mfma_f32_16x16x32_bf16 v[208:211], v[112:115], v[160:163], v[208:211]
  v_mfma_f32_16x16x32_bf16 v[212:215], v[116:119], v[160:163], v[212:215]
  v_mfma_f32_16x16x32_bf16 v[216:219], v[120:123], v[160:163], v[216:219]
  v_mfma_f32_16x16x32_bf16 v[220:223], v[124:127], v[160:163], v[220:223]
  s_waitcnt lgkmcnt(0)
  v_mfma_f32_16x16x32_bf16 v[220:223], v[64:67], v[156:159], v[220:223]
  ds_read_b128 v[160:163], v3 offset:4032
  v_mfma_f32_16x16x32_bf16 v[216:219], v[64:67], v[152:155], v[216:219]
  ds_read_b128 v[164:167], v3 offset:3520
  v_mfma_f32_16x16x32_bf16 v[212:215], v[64:67], v[148:151], v[212:215]
  ds_read_b128 v[168:171], v3 offset:3008
  v_mfma_f32_16x16x32_bf16 v[220:223], v[68:71], v[152:155], v[220:223]
  ds_read_b128 v[172:175], v3 offset:2496
  v_mfma_f32_16x16x32_bf16 v[216:219], v[68:71], v[148:151], v[216:219]
  ds_read_b128 v[176:179], v3 offset:1984
  v_mfma_f32_16x16x32_bf16 v[208:211], v[64:67], v[144:147], v[208:211]
  ds_read_b128 v[180:183], v3 offset:1472
  v_mfma_f32_16x16x32_bf16 v[220:223], v[72:75], v[148:151], v[220:223]
  ds_read_b128 v[184:187], v3 offset:960
  v_mfma_f32_16x16x32_bf16 v[212:215], v[68:71], v[144:147], v[212:215]
  ds_read_b128 v[188:191], v3 offset:448
  v_mfma_f32_16x16x32_bf16 v[216:219], v[72:75], v[144:147], v[216:219]
  ds_read_b64 v[96:97], v2 offset:448
  v_mfma_f32_16x16x32_bf16 v[220:223], v[76:79], v[144:147], v[220:223]
  ds_read_b64 v[98:99], v2 offset:456
  v_mfma_f32_16x16x32_bf16 v[204:207], v[64:67], v[140:143], v[204:207]
  ds_read_b64 v[100:101], v2 offset:960
  v_mfma_f32_16x16x32_bf16 v[208:211], v[68:71], v[140:143], v[208:211]
  ds_read_b64 v[102:103], v2 offset:968
  v_mfma_f32_16x16x32_bf16 v[212:215], v[72:75], v[140:143], v[212:215]
  ds_read_b64 v[104:105], v2 offset:1472
  v_mfma_f32_16x16x32_bf16 v[216:219], v[76:79], v[140:143], v[216:219]
  ds_read_b64 v[106:107], v2 offset:1480
  v_mfma_f32_16x16x32_bf16 v[220:223], v[80:83], v[140:143], v[220:223]
  ds_read_b64 v[108:109], v2 offset:1984
  v_mfma_f32_16x16x32_bf16 v[200:203], v[64:67], v[136:139], v[200:203]
  ds_read_b64 v[110:111], v2 offset:1992
  v_mfma_f32_16x16x32_bf16 v[204:207], v[68:71], v[136:139], v[204:207]
  ds_read_b64 v[112:113], v2 offset:2496
  v_mfma_f32_16x16x32_bf16 v[208:211], v[72:75], v[136:139], v[208:211]
  ds_read_b64 v[114:115], v2 offset:2504
  v_mfma_f32_16x16x32_bf16 v[212:215], v[76:79], v[136:139], v[212:215]
  ds_read_b64 v[116:117], v2 offset:3008
  v_mfma_f32_16x16x32_bf16 v[216:219], v[80:83], v[136:139], v[216:219]
  ds_read_b64 v[118:119], v2 offset:3016
  v_mfma_f32_16x16x32_bf16 v[220:223], v[84:87], v[136:139], v[220:223]
  ds_read_b64 v[120:121], v2 offset:3520
  v_mfma_f32_16x16x32_bf16 v[196:199], v[64:67], v[132:135], v[196:199]
  ds_read_b64 v[122:123], v2 offset:3528
  v_mfma_f32_16x16x32_bf16 v[200:203], v[68:71], v[132:135], v[200:203]
  ds_read_b64 v[124:125], v2 offset:4032
  v_mfma_f32_16x16x32_bf16 v[204:207], v[72:75], v[132:135], v[204:207]
  ds_read_b64 v[126:127], v2 offset:4040
  v_mfma_f32_16x16x32_bf16 v[208:211], v[76:79], v[132:135], v[208:211]
  v_mfma_f32_16x16x32_bf16 v[212:215], v[80:83], v[132:135], v[212:215]
  v_mfma_f32_16x16x32_bf16 v[216:219], v[84:87], v[132:135], v[216:219]
  v_mfma_f32_16x16x32_bf16 v[220:223], v[88:91], v[132:135], v[220:223]
  v_mfma_f32_16x16x32_bf16 v[192:195], v[64:67], v[128:131], v[192:195]
  v_mfma_f32_16x16x32_bf16 v[196:199], v[68:71], v[128:131], v[196:199]
  v_mfma_f32_16x16x32_bf16 v[200:203], v[72:75], v[128:131], v[200:203]
  v_mfma_f32_16x16x32_bf16 v[204:207], v[76:79], v[128:131], v[204:207]
  v_mfma_f32_16x16x32_bf16 v[208:211], v[80:83], v[128:131], v[208:211]
  v_mfma_f32_16x16x32_bf16 v[212:215], v[84:87], v[128:131], v[212:215]
  v_mfma_f32_16x16x32_bf16 v[216:219], v[88:91], v[128:131], v[216:219]
  v_mfma_f32_16x16x32_bf16 v[220:223], v[92:95], v[128:131], v[220:223]
  s_waitcnt lgkmcnt(0)
  v_mfma_f32_16x16x32_bf16 v[220:223], v[96:99], v[188:191], v[220:223]
  v_mfma_f32_16x16x32_bf16 v[216:219], v[96:99], v[184:187], v[216:219]
  v_mfma_f32_16x16x32_bf16 v[212:215], v[96:99], v[180:183], v[212:215]
  v_mfma_f32_16x16x32_bf16 v[220:223], v[100:103], v[184:187], v[220:223]
  v_mfma_f32_16x16x32_bf16 v[216:219], v[100:103], v[180:183], v[216:219]
  v_mfma_f32_16x16x32_bf16 v[208:211], v[96:99], v[176:179], v[208:211]
  v_mfma_f32_16x16x32_bf16 v[220:223], v[104:107], v[180:183], v[220:223]
  v_mfma_f32_16x16x32_bf16 v[212:215], v[100:103], v[176:179], v[212:215]
  v_mfma_f32_16x16x32_bf16 v[216:219], v[104:107], v[176:179], v[216:219]
  v_mfma_f32_16x16x32_bf16 v[220:223], v[108:111], v[176:179], v[220:223]
  v_mfma_f32_16x16x32_bf16 v[204:207], v[96:99], v[172:175], v[204:207]
  v_mfma_f32_16x16x32_bf16 v[208:211], v[100:103], v[172:175], v[208:211]
  v_mfma_f32_16x16x32_bf16 v[212:215], v[104:107], v[172:175], v[212:215]
  v_mfma_f32_16x16x32_bf16 v[216:219], v[108:111], v[172:175], v[216:219]
  v_mfma_f32_16x16x32_bf16 v[220:223], v[112:115], v[172:175], v[220:223]
  v_mfma_f32_16x16x32_bf16 v[200:203], v[96:99], v[168:171], v[200:203]
  v_mfma_f32_16x16x32_bf16 v[204:207], v[100:103], v[168:171], v[204:207]
  v_mfma_f32_16x16x32_bf16 v[208:211], v[104:107], v[168:171], v[208:211]
  v_mfma_f32_16x16x32_bf16 v[212:215], v[108:111], v[168:171], v[212:215]
  v_mfma_f32_16x16x32_bf16 v[216:219], v[112:115], v[168:171], v[216:219]
  v_mfma_f32_16x16x32_bf16 v[220:223], v[116:119], v[168:171], v[220:223]
  v_mfma_f32_16x16x32_bf16 v[196:199], v[96:99], v[164:167], v[196:199]
  v_mfma_f32_16x16x32_bf16 v[200:203], v[100:103], v[164:167], v[200:203]
  v_mfma_f32_16x16x32_bf16 v[204:207], v[104:107], v[164:167], v[204:207]
  v_mfma_f32_16x16x32_bf16 v[208:211], v[108:111], v[164:167], v[208:211]
  v_mfma_f32_16x16x32_bf16 v[212:215], v[112:115], v[164:167], v[212:215]
  v_mfma_f32_16x16x32_bf16 v[216:219], v[116:119], v[164:167], v[216:219]
  v_mfma_f32_16x16x32_bf16 v[220:223], v[120:123], v[164:167], v[220:223]
  v_mfma_f32_16x16x32_bf16 v[192:195], v[96:99], v[160:163], v[192:195]
  v_mfma_f32_16x16x32_bf16 v[196:199], v[100:103], v[160:163], v[196:199]
  v_mfma_f32_16x16x32_bf16 v[200:203], v[104:107], v[160:163], v[200:203]
  v_mfma_f32_16x16x32_bf16 v[204:207], v[108:111], v[160:163], v[204:207]
  v_mfma_f32_16x16x32_bf16 v[208:211], v[112:115], v[160:163], v[208:211]
  v_mfma_f32_16x16x32_bf16 v[212:215], v[116:119], v[160:163], v[212:215]
  v_mfma_f32_16x16x32_bf16 v[216:219], v[120:123], v[160:163], v[216:219]
  v_mfma_f32_16x16x32_bf16 v[220:223], v[124:127], v[160:163], v[220:223]
  v_lshlrev_b32 v11, 16, v11
  v_lshlrev_b32 v15, 5, v13
  v_lshl_add_u32 v15, v14, 3, v15
  s_add_u32 s11, s55, 504
  v_sub_u32 v16, s11, v15
  s_add_u32 s11, s55, 5120
  v_add_u32 v17, s11, v15
  s_mov_b32 s12, 0xffff0000
  ds_read_b64 v[64:65], v16 offset:3584
  ds_read_b64 v[66:67], v16 offset:3072
  ds_read_b64 v[68:69], v16 offset:2560
  ds_read_b64 v[70:71], v16 offset:2048
  ds_read_b64 v[72:73], v16 offset:1536
  ds_read_b64 v[74:75], v16 offset:1024
  ds_read_b64 v[76:77], v16 offset:512
  ds_read_b64 v[78:79], v16 offset:0
  s_waitcnt lgkmcnt(0)
  v_and_b32 v96, s12, v65
  v_lshlrev_b32 v97, 16, v65
  v_and_b32 v98, s12, v64
  v_lshlrev_b32 v99, 16, v64
  v_pk_fma_f32 v[192:193], v[96:97], v[10:11], v[192:193] op_sel:[0,1,0] op_sel_hi:[1,1,1]
  v_pk_fma_f32 v[194:195], v[98:99], v[10:11], v[194:195] op_sel:[0,1,0] op_sel_hi:[1,1,1]
  v_cvt_pk_bf16_f32 v100, v192, v193
  v_cvt_pk_bf16_f32 v101, v194, v195
  ds_write_b64 v17, v[100:101] offset:0
  v_and_b32 v104, s12, v67
  v_lshlrev_b32 v105, 16, v67
  v_and_b32 v106, s12, v66
  v_lshlrev_b32 v107, 16, v66
  v_pk_fma_f32 v[196:197], v[104:105], v[10:11], v[196:197] op_sel:[0,1,0] op_sel_hi:[1,1,1]
  v_pk_fma_f32 v[198:199], v[106:107], v[10:11], v[198:199] op_sel:[0,1,0] op_sel_hi:[1,1,1]
  v_cvt_pk_bf16_f32 v108, v196, v197
  v_cvt_pk_bf16_f32 v109, v198, v199
  ds_write_b64 v17, v[108:109] offset:512
  v_and_b32 v96, s12, v69
  v_lshlrev_b32 v97, 16, v69
  v_and_b32 v98, s12, v68
  v_lshlrev_b32 v99, 16, v68
  v_pk_fma_f32 v[200:201], v[96:97], v[10:11], v[200:201] op_sel:[0,1,0] op_sel_hi:[1,1,1]
  v_pk_fma_f32 v[202:203], v[98:99], v[10:11], v[202:203] op_sel:[0,1,0] op_sel_hi:[1,1,1]
  v_cvt_pk_bf16_f32 v100, v200, v201
  v_cvt_pk_bf16_f32 v101, v202, v203
  ds_write_b64 v17, v[100:101] offset:1024
  v_and_b32 v104, s12, v71
  v_lshlrev_b32 v105, 16, v71
  v_and_b32 v106, s12, v70
  v_lshlrev_b32 v107, 16, v70
  v_pk_fma_f32 v[204:205], v[104:105], v[10:11], v[204:205] op_sel:[0,1,0] op_sel_hi:[1,1,1]
  v_pk_fma_f32 v[206:207], v[106:107], v[10:11], v[206:207] op_sel:[0,1,0] op_sel_hi:[1,1,1]
  v_cvt_pk_bf16_f32 v108, v204, v205
  v_cvt_pk_bf16_f32 v109, v206, v207
  ds_write_b64 v17, v[108:109] offset:1536
  v_and_b32 v96, s12, v73
  v_lshlrev_b32 v97, 16, v73
  v_and_b32 v98, s12, v72
  v_lshlrev_b32 v99, 16, v72
  v_pk_fma_f32 v[208:209], v[96:97], v[10:11], v[208:209] op_sel:[0,1,0] op_sel_hi:[1,1,1]
  v_pk_fma_f32 v[210:211], v[98:99], v[10:11], v[210:211] op_sel:[0,1,0] op_sel_hi:[1,1,1]
  v_cvt_pk_bf16_f32 v100, v208, v209
  v_cvt_pk_bf16_f32 v101, v210, v211
  ds_write_b64 v17, v[100:101] offset:2048
  v_and_b32 v104, s12, v75
  v_lshlrev_b32 v105, 16, v75
  v_and_b32 v106, s12, v74
  v_lshlrev_b32 v107, 16, v74
  v_pk_fma_f32 v[212:213], v[104:105], v[10:11], v[212:213] op_sel:[0,1,0] op_sel_hi:[1,1,1]
  v_pk_fma_f32 v[214:215], v[106:107], v[10:11], v[214:215] op_sel:[0,1,0] op_sel_hi:[1,1,1]
  v_cvt_pk_bf16_f32 v108, v212, v213
  v_cvt_pk_bf16_f32 v109, v214, v215
  ds_write_b64 v17, v[108:109] offset:2560
  v_and_b32 v96, s12, v77
  v_lshlrev_b32 v97, 16, v77
  v_and_b32 v98, s12, v76
  v_lshlrev_b32 v99, 16, v76
  v_pk_fma_f32 v[216:217], v[96:97], v[10:11], v[216:217] op_sel:[0,1,0] op_sel_hi:[1,1,1]
  v_pk_fma_f32 v[218:219], v[98:99], v[10:11], v[218:219] op_sel:[0,1,0] op_sel_hi:[1,1,1]
  v_cvt_pk_bf16_f32 v100, v216, v217
  v_cvt_pk_bf16_f32 v101, v218, v219
  ds_write_b64 v17, v[100:101] offset:3072
  v_and_b32 v104, s12, v79
  v_lshlrev_b32 v105, 16, v79
  v_and_b32 v106, s12, v78
  v_lshlrev_b32 v107, 16, v78
  v_pk_fma_f32 v[220:221], v[104:105], v[10:11], v[220:221] op_sel:[0,1,0] op_sel_hi:[1,1,1]
  v_pk_fma_f32 v[222:223], v[106:107], v[10:11], v[222:223] op_sel:[0,1,0] op_sel_hi:[1,1,1]
  v_cvt_pk_bf16_f32 v108, v220, v221
  v_cvt_pk_bf16_f32 v109, v222, v223
  ds_write_b64 v17, v[108:109] offset:3584
  v_mov_b32 v8, 1
  v_mov_b32 v9, 160768
  s_waitcnt lgkmcnt(0)
  ds_write_b32 v7, v8
  s_mov_b32 s16, 0
K2_SPIN:
  s_add_u32 s16, s16, 1
  s_cmp_ge_u32 s16, 4194304
  s_cbranch_scc1 K2_SPINOK
  ds_read_b128 v[20:23], v9
  s_waitcnt lgkmcnt(0)
  v_and_b32 v20, v20, v21
  v_and_b32 v22, v22, v23
  v_and_b32 v20, v20, v22
  s_nop 0
  v_readfirstlane_b32 s11, v20
  s_cmp_eq_u32 s11, 1
  s_cbranch_scc0 K2_SPIN
K2_SPINOK:
  s_lshl_b32 s11, s53, 10
  s_add_u32 s11, s11, 5120
  v_lshlrev_b32 v15, 2, v1
  v_add_u32 v15, s11, v15
  v_add_u32 v16, 43520, v15
  s_mov_b32 s12, 0x05040100
  s_mov_b32 s13, 0x07060302
  s_lshl_b32 s14, s2, 14
  s_lshl_b32 s15, s53, 12
  s_add_u32 s14, s14, s15
  s_add_u32 s14, s14, 11534336
  ds_read_b32 v64, v15 offset:0
  ds_read_b32 v65, v15 offset:21760
  ds_read_b32 v66, v16 offset:0
  ds_read_b32 v67, v16 offset:21760
  ds_read_b32 v72, v15 offset:256
  ds_read_b32 v73, v15 offset:22016
  ds_read_b32 v74, v16 offset:256
  ds_read_b32 v75, v16 offset:22016
  ds_read_b32 v80, v15 offset:512
  ds_read_b32 v81, v15 offset:22272
  ds_read_b32 v82, v16 offset:512
  ds_read_b32 v83, v16 offset:22272
  ds_read_b32 v88, v15 offset:768
  ds_read_b32 v89, v15 offset:22528
  ds_read_b32 v90, v16 offset:768
  ds_read_b32 v91, v16 offset:22528
  s_waitcnt lgkmcnt(12)
  v_perm_b32 v68, v65, v64, s12
  v_perm_b32 v69, v67, v66, s12
  v_perm_b32 v70, v65, v64, s13
  v_perm_b32 v71, v67, v66, s13
  buffer_store_dwordx4 v[68:71], v4, s[32:35], s14 offen offset:0 sc1
  s_waitcnt lgkmcnt(8)
  v_perm_b32 v76, v73, v72, s12
  v_perm_b32 v77, v75, v74, s12
  v_perm_b32 v78, v73, v72, s13
  v_perm_b32 v79, v75, v74, s13
  buffer_store_dwordx4 v[76:79], v4, s[32:35], s14 offen offset:1024 sc1
  s_waitcnt lgkmcnt(4)
  v_perm_b32 v84, v81, v80, s12
  v_perm_b32 v85, v83, v82, s12
  v_perm_b32 v86, v81, v80, s13
  v_perm_b32 v87, v83, v82, s13
  buffer_store_dwordx4 v[84:87], v4, s[32:35], s14 offen offset:2048 sc1
  s_waitcnt lgkmcnt(0)
  v_perm_b32 v92, v89, v88, s12
  v_perm_b32 v93, v91, v90, s12
  v_perm_b32 v94, v89, v88, s13
  v_perm_b32 v95, v91, v90, s13
  buffer_store_dwordx4 v[92:95], v4, s[32:35], s14 offen offset:3072 sc1
  s_mul_i32 s11, s2, 3277
  s_lshr_b32 s11, s11, 16
  s_mul_i32 s12, s11, 20
  s_sub_u32 s12, s2, s12
  s_lshl_b32 s12, s12, 2
  s_lshl_b32 s11, s11, 12
  s_add_u32 s11, s11, s12
  s_add_u32 s11, s11, 14712832
  v_mov_b32 v8, 1
  v_lshlrev_b32 v9, 7, v1
  v_add_u32 v9, s11, v9
  s_mov_b64 exec, 1
  s_waitcnt vmcnt(0)
  ds_add_rtn_u32 v19, v18, v8
  s_waitcnt lgkmcnt(0)
  v_readfirstlane_b32 s12, v19
  s_cmp_eq_u32 s12, 3
  s_cbranch_scc0 K2_NOSIG
  s_mov_b32 exec_lo, -1
  buffer_store_dword v8, v9, s[32:35], 0 offen sc1
K2_NOSIG:
  s_endpgm
K2_END:
  s_endpgm
.section .rodata,"a"
.p2align 6
.amdhsa_kernel k1_kernel
  .amdhsa_next_free_vgpr 256
  .amdhsa_next_free_sgpr 102
  .amdhsa_accum_offset 256
  .amdhsa_group_segment_fixed_size 0
  .amdhsa_kernarg_size 112
  .amdhsa_user_sgpr_count 2
  .amdhsa_user_sgpr_kernarg_segment_ptr 1
  .amdhsa_system_sgpr_workgroup_id_x 1
.end_amdhsa_kernel
.amdhsa_kernel k2_kernel
  .amdhsa_next_free_vgpr 256
  .amdhsa_next_free_sgpr 102
  .amdhsa_accum_offset 256
  .amdhsa_group_segment_fixed_size 0
  .amdhsa_kernarg_size 112
  .amdhsa_user_sgpr_count 2
  .amdhsa_user_sgpr_kernarg_segment_ptr 1
  .amdhsa_system_sgpr_workgroup_id_x 1
.end_amdhsa_kernel
```
